```python
import torch

def _softmax(x, axis=-1):
    return torch.softmax(x, dim=axis)
def _gelu(x):
    return torch.nn.functional.gelu(x, approximate="tanh")
def _silu(x):
    return torch.nn.functional.silu(x)
def _sigmoid(x):
    return torch.sigmoid(x)
def _layernorm(x, axis=-1, eps=1e-5):
    m = x.mean(dim=axis, keepdim=True)
    v = x.var(dim=axis, keepdim=True, unbiased=False)
    return (x - m) / torch.sqrt(v + eps)
def _scatter_add(tgt, idx, src, axis=0):
    return tgt.clone().index_add_(axis, idx, src)
def _segment_sum(src, seg, n):
    out = torch.zeros((n,) + src.shape[1:], dtype=src.dtype)
    return out.index_add_(0, seg, src)
def _pad(x, pw):
    flat = tuple(v for pair in reversed(pw) for v in pair)
    return torch.nn.functional.pad(x, flat)

kernel_name = 'concat_heads__mha_block_cached__gqa_block_cached__decode'

def setup_inputs():

    _w = (lambda a: (lambda t: t.to(torch.bfloat16) if t.is_floating_point() else t)(torch.as_tensor(a)))
    def _A_setup():
        B, Sq, D = 1, 1, 640
        H, Sk, Dh = 32, 8192, 128
        return {
            "x": _w((lambda *s: torch.randn(*s, dtype=torch.bfloat16) * 0.8)(B, Sq, D)),
            "k_cache": _w((lambda *s: torch.randn(*s, dtype=torch.bfloat16) * 1.6)(B, H, Sk, Dh)),
            "v_cache": _w((lambda *s: torch.randn(*s, dtype=torch.bfloat16) * 0.2)(B, H, Sk, Dh)),
            "wq": _w((lambda *s: torch.randn(*s, dtype=torch.bfloat16) * 1.6)(D, H * Dh) * (D ** -0.5)),
            "wo": _w((lambda *s: torch.randn(*s, dtype=torch.bfloat16) * 0.2)(H * Dh, D) * ((H * Dh) ** -0.5)),
        }
    _A_in = _A_setup()

    def _B_setup():
        B, Sq, D = 1, 1, 640
        Hq, Hkv, Sk, Dh = 32, 32, 8192, 128
        assert Hq % Hkv == 0, (Hq, Hkv)
        return {
            "x": _w((lambda *s: torch.randn(*s, dtype=torch.bfloat16) * 0.8)(B, Sq, D)),
            "k_cache": _w((lambda *s: torch.randn(*s, dtype=torch.bfloat16) * 1.6)(B, Hkv, Sk, Dh)),
            "v_cache": _w((lambda *s: torch.randn(*s, dtype=torch.bfloat16) * 0.2)(B, Hkv, Sk, Dh)),
            "wq": _w((lambda *s: torch.randn(*s, dtype=torch.bfloat16) * 1.6)(D, Hq * Dh) * (D ** -0.5)),
            "wo": _w((lambda *s: torch.randn(*s, dtype=torch.bfloat16) * 0.2)(Hq * Dh, D) * ((Hq * Dh) ** -0.5)),
        }
    _B_in = _B_setup()

    return {
        "A_x": _A_in["x"],
        "A_k_cache": _A_in["k_cache"],
        "A_v_cache": _A_in["v_cache"],
        "A_wq": _A_in["wq"],
        "A_wo": _A_in["wo"],
        "B_x": _B_in["x"],
        "B_k_cache": _B_in["k_cache"],
        "B_v_cache": _B_in["v_cache"],
        "B_wq": _B_in["wq"],
        "B_wo": _B_in["wo"],
    }

def reference(A_x, A_k_cache, A_v_cache, A_wq, A_wo, B_x, B_k_cache, B_v_cache, B_wq, B_wo):
    def _A_ref(x, k_cache, v_cache, wq, wo):
        B, Sq, D = x.shape
        H, Dh = 32, 128
        q = (lambda x, *d: x.permute(*d))((x @ wq).reshape(B, Sq, H, Dh), 0, 2, 1, 3)
        scores = torch.einsum("bhqd,bhkd->bhqk", q, k_cache) * (Dh ** -0.5)
        p = _softmax(scores, axis=-1)
        o = torch.einsum("bhqk,bhkd->bhqd", p, v_cache)
        return (lambda x, *d: x.permute(*d))(o, 0, 2, 1, 3).reshape(B, Sq, H * Dh) @ wo

    def _B_ref(x, k_cache, v_cache, wq, wo):
        B, Sq, D = x.shape
        Hq, Dh = 32, 128
        Hkv = k_cache.shape[1]
        rep = Hq // Hkv
        q = (lambda x, *d: x.permute(*d))((x @ wq).reshape(B, Sq, Hq, Dh), 0, 2, 1, 3)
        k = (lambda x, n, axis: torch.repeat_interleave(x, n, dim=axis))(k_cache, rep, axis=1)
        v = (lambda x, n, axis: torch.repeat_interleave(x, n, dim=axis))(v_cache, rep, axis=1)
        scores = torch.einsum("bhqd,bhkd->bhqk", q, k) * (Dh ** -0.5)
        p = _softmax(scores, axis=-1)
        o = torch.einsum("bhqk,bhkd->bhqd", p, v)
        return (lambda x, *d: x.permute(*d))(o, 0, 2, 1, 3).reshape(B, Sq, Hq * Dh) @ wo

    a = _A_ref(A_x, A_k_cache, A_v_cache, A_wq, A_wo)
    b = _B_ref(B_x, B_k_cache, B_v_cache, B_wq, B_wo)
    return torch.concatenate([a, b], axis=-1)
```

```asm
; @launch grid=(256,1,1) block=(512,1,1) lds=16384
.amdgcn_target "amdgcn-amd-amdhsa--gfx950"
.text
.globl concat_heads__mha_block_cached__gqa_block_cached__decode_kernel
.p2align 8
.type concat_heads__mha_block_cached__gqa_block_cached__decode_kernel,@function
concat_heads__mha_block_cached__gqa_block_cached__decode_kernel:
    s_cmp_ge_u32 s2, 256
    s_cbranch_scc1 L_end
    s_and_b32 s26, s2, 7
    s_lshr_b32 s27, s2, 3
    s_and_b32 s28, s27, 3
    s_lshr_b32 s29, s27, 2
    s_lshl_b32 s29, s29, 3
    s_add_u32 s29, s29, s26
    s_lshr_b32 s31, s29, 5
    s_mul_i32 s3, s31, 40
    s_load_dwordx8 s[8:15], s[0:1], s3
    s_load_dwordx2 s[16:17], s[0:1], s3 offset:32
    s_load_dwordx4 s[20:23], s[0:1], 80
    s_load_dwordx2 s[24:25], s[0:1], 96
    s_and_b32 s30, s29, 31
    v_lshrrev_b32 v1, 6, v0
    v_and_b32 v2, 63, v0
    v_readfirstlane_b32 s32, v1
    v_and_b32 v3, 15, v0
    v_bfe_u32 v4, v0, 4, 2
    v_and_b32 v5, 1, v0
    v_lshlrev_b32 v5, 4, v5
    v_mov_b32 v6, 0xffff
    v_lshlrev_b32 v6, v5, v6
    v_lshrrev_b32 v7, 1, v3
    v_cmp_eq_u32 vcc, 0, v7
    s_nop 1
    v_cndmask_b32 v56, 0, v6, vcc
    v_cmp_eq_u32 vcc, 1, v7
    s_nop 1
    v_cndmask_b32 v57, 0, v6, vcc
    v_cmp_eq_u32 vcc, 2, v7
    s_nop 1
    v_cndmask_b32 v58, 0, v6, vcc
    v_cmp_eq_u32 vcc, 3, v7
    s_nop 1
    v_cndmask_b32 v59, 0, v6, vcc
    s_cmp_ge_u32 s32, 4
    s_cbranch_scc1 L_stream
    s_setprio 2
    v_mul_u32_u24 v8, 80, v4
    s_mul_i32 s52, s32, 320
    s_mul_i32 s55, s28, 20
    s_add_u32 s52, s52, s55
    v_min_u32 v5, 4, v3
    v_lshl_add_u32 v5, v5, 2, v8
    v_mul_u32_u24 v9, 0x50000, v4
    v_lshl_add_u32 v9, v3, 4, v9
    s_mul_i32 s53, s32, 0x140000
    s_lshl_b32 s54, s30, 8
    s_add_u32 s53, s53, s54
    s_mul_i32 s55, s28, 0x14000
    s_add_u32 s56, s55, s53
    v_mov_b32 v80, 0
    v_mov_b32 v81, 0
    v_mov_b32 v82, 0
    v_mov_b32 v83, 0
    v_mov_b32 v14, 2080
    ds_write_b128 v14, v[80:83]
    v_lshlrev_b32 v15, 4, v2
    s_mov_b32 s34, 0
    s_lshl_b32 s54, s29, 11
    s_add_u32 s54, s54, 131072
    s_add_u32 s54, s54, s34
    s_lshl_b32 s55, s28, 9
    s_add_u32 s54, s54, s55
    s_lshl_b32 s55, s2, 7
    s_add_u32 s34, s34, s55
    s_add_u32 s34, s34, 393216
    v_add_u32 v36, s54, v15
    v_xor_b32 v37, 512, v36
    v_xor_b32 v38, 1024, v36
    v_xor_b32 v39, 1536, v36
    s_cmp_lg_u32 s32, 0
    s_waitcnt lgkmcnt(0)
    s_cbranch_scc1 L_h_nosnap
    s_mov_b32 exec_hi, 0
    global_load_dwordx4 v[136:139], v36, s[24:25] sc1
    global_load_dwordx4 v[140:143], v37, s[24:25] sc1
    global_load_dwordx4 v[144:147], v38, s[24:25] sc1
    global_load_dwordx4 v[148:151], v39, s[24:25] sc1
    s_mov_b64 exec, -1
L_h_nosnap:
    s_mov_b32 s36, s8
    s_mov_b32 s37, s9
    s_mov_b32 s38, 1280
    s_mov_b32 s39, 0x20000
    s_mov_b32 s40, s14
    s_mov_b32 s41, s15
    s_mov_b32 s42, 5242880
    s_mov_b32 s43, 0x20000
    buffer_load_dword v16, v5, s[36:39], s52 offen
    buffer_load_dwordx4 v[96:99], v9, s[40:43], s56 offen nt
    s_add_u32 s56, s56, 0x2000
    buffer_load_dwordx4 v[100:103], v9, s[40:43], s56 offen nt
    s_add_u32 s56, s56, 0x2000
    buffer_load_dwordx4 v[104:107], v9, s[40:43], s56 offen nt
    s_add_u32 s56, s56, 0x2000
    buffer_load_dwordx4 v[108:111], v9, s[40:43], s56 offen nt
    s_add_u32 s56, s56, 0x2000
    buffer_load_dwordx4 v[112:115], v9, s[40:43], s56 offen nt
    s_add_u32 s56, s56, 0x2000
    buffer_load_dwordx4 v[116:119], v9, s[40:43], s56 offen nt
    s_add_u32 s56, s56, 0x2000
    buffer_load_dwordx4 v[120:123], v9, s[40:43], s56 offen nt
    s_add_u32 s56, s56, 0x2000
    buffer_load_dwordx4 v[124:127], v9, s[40:43], s56 offen nt
    s_add_u32 s56, s56, 0x2000
    buffer_load_dwordx4 v[128:131], v9, s[40:43], s56 offen nt
    s_add_u32 s56, s56, 0x2000
    buffer_load_dwordx4 v[132:135], v9, s[40:43], s56 offen nt
    s_barrier
    s_mov_b32 s57, 0x01000100
    s_mov_b32 s58, 0x03020302
    s_mov_b32 s44, s16
    s_mov_b32 s45, s17
    s_mov_b32 s46, 5242880
    s_mov_b32 s47, 0x20000
    v_lshlrev_b32 v13, 5, v3
    v_lshl_add_u32 v13, v4, 4, v13
    s_lshl_b32 s54, s32, 9
    v_add_u32 v14, s54, v13
    v_mov_b32 v10, 2084
    v_mov_b32 v11, 1
    s_waitcnt vmcnt(10)
    v_perm_b32 v18, v16, v16, s57
    v_perm_b32 v19, v16, v16, s58
    s_nop 1
    v_and_b32_dpp v44, v18, v56 row_newbcast:0 row_mask:0xf bank_mask:0xf
    v_and_b32_dpp v45, v18, v57 row_newbcast:0 row_mask:0xf bank_mask:0xf
    v_and_b32_dpp v46, v18, v58 row_newbcast:0 row_mask:0xf bank_mask:0xf
    v_and_b32_dpp v47, v18, v59 row_newbcast:0 row_mask:0xf bank_mask:0xf
    v_and_b32_dpp v48, v19, v56 row_newbcast:0 row_mask:0xf bank_mask:0xf
    v_and_b32_dpp v49, v19, v57 row_newbcast:0 row_mask:0xf bank_mask:0xf
    v_and_b32_dpp v50, v19, v58 row_newbcast:0 row_mask:0xf bank_mask:0xf
    v_and_b32_dpp v51, v19, v59 row_newbcast:0 row_mask:0xf bank_mask:0xf
    s_waitcnt vmcnt(9)
    v_mfma_f32_16x16x32_bf16 v[60:63], v[44:47], v[96:99], 0
    v_and_b32_dpp v44, v18, v56 row_newbcast:1 row_mask:0xf bank_mask:0xf
    v_and_b32_dpp v45, v18, v57 row_newbcast:1 row_mask:0xf bank_mask:0xf
    v_and_b32_dpp v46, v18, v58 row_newbcast:1 row_mask:0xf bank_mask:0xf
    v_and_b32_dpp v47, v18, v59 row_newbcast:1 row_mask:0xf bank_mask:0xf
    s_waitcnt vmcnt(8)
    v_mfma_f32_16x16x32_bf16 v[60:63], v[48:51], v[100:103], v[60:63]
    v_and_b32_dpp v48, v19, v56 row_newbcast:1 row_mask:0xf bank_mask:0xf
    v_and_b32_dpp v49, v19, v57 row_newbcast:1 row_mask:0xf bank_mask:0xf
    v_and_b32_dpp v50, v19, v58 row_newbcast:1 row_mask:0xf bank_mask:0xf
    v_and_b32_dpp v51, v19, v59 row_newbcast:1 row_mask:0xf bank_mask:0xf
    s_waitcnt vmcnt(7)
    v_mfma_f32_16x16x32_bf16 v[60:63], v[44:47], v[104:107], v[60:63]
    v_and_b32_dpp v44, v18, v56 row_newbcast:2 row_mask:0xf bank_mask:0xf
    v_and_b32_dpp v45, v18, v57 row_newbcast:2 row_mask:0xf bank_mask:0xf
    v_and_b32_dpp v46, v18, v58 row_newbcast:2 row_mask:0xf bank_mask:0xf
    v_and_b32_dpp v47, v18, v59 row_newbcast:2 row_mask:0xf bank_mask:0xf
    s_waitcnt vmcnt(6)
    v_mfma_f32_16x16x32_bf16 v[60:63], v[48:51], v[108:111], v[60:63]
    v_and_b32_dpp v48, v19, v56 row_newbcast:2 row_mask:0xf bank_mask:0xf
    v_and_b32_dpp v49, v19, v57 row_newbcast:2 row_mask:0xf bank_mask:0xf
    v_and_b32_dpp v50, v19, v58 row_newbcast:2 row_mask:0xf bank_mask:0xf
    v_and_b32_dpp v51, v19, v59 row_newbcast:2 row_mask:0xf bank_mask:0xf
    s_waitcnt vmcnt(5)
    v_mfma_f32_16x16x32_bf16 v[60:63], v[44:47], v[112:115], v[60:63]
    v_and_b32_dpp v44, v18, v56 row_newbcast:3 row_mask:0xf bank_mask:0xf
    v_and_b32_dpp v45, v18, v57 row_newbcast:3 row_mask:0xf bank_mask:0xf
    v_and_b32_dpp v46, v18, v58 row_newbcast:3 row_mask:0xf bank_mask:0xf
    v_and_b32_dpp v47, v18, v59 row_newbcast:3 row_mask:0xf bank_mask:0xf
    s_waitcnt vmcnt(4)
    v_mfma_f32_16x16x32_bf16 v[60:63], v[48:51], v[116:119], v[60:63]
    v_and_b32_dpp v48, v19, v56 row_newbcast:3 row_mask:0xf bank_mask:0xf
    v_and_b32_dpp v49, v19, v57 row_newbcast:3 row_mask:0xf bank_mask:0xf
    v_and_b32_dpp v50, v19, v58 row_newbcast:3 row_mask:0xf bank_mask:0xf
    v_and_b32_dpp v51, v19, v59 row_newbcast:3 row_mask:0xf bank_mask:0xf
    s_waitcnt vmcnt(3)
    v_mfma_f32_16x16x32_bf16 v[60:63], v[44:47], v[120:123], v[60:63]
    v_and_b32_dpp v44, v18, v56 row_newbcast:4 row_mask:0xf bank_mask:0xf
    v_and_b32_dpp v45, v18, v57 row_newbcast:4 row_mask:0xf bank_mask:0xf
    v_and_b32_dpp v46, v18, v58 row_newbcast:4 row_mask:0xf bank_mask:0xf
    v_and_b32_dpp v47, v18, v59 row_newbcast:4 row_mask:0xf bank_mask:0xf
    s_waitcnt vmcnt(2)
    v_mfma_f32_16x16x32_bf16 v[60:63], v[48:51], v[124:127], v[60:63]
    v_and_b32_dpp v48, v19, v56 row_newbcast:4 row_mask:0xf bank_mask:0xf
    v_and_b32_dpp v49, v19, v57 row_newbcast:4 row_mask:0xf bank_mask:0xf
    v_and_b32_dpp v50, v19, v58 row_newbcast:4 row_mask:0xf bank_mask:0xf
    v_and_b32_dpp v51, v19, v59 row_newbcast:4 row_mask:0xf bank_mask:0xf
    s_waitcnt vmcnt(1)
    v_mfma_f32_16x16x32_bf16 v[60:63], v[44:47], v[128:131], v[60:63]
    s_nop 1
    s_waitcnt vmcnt(0)
    v_mfma_f32_16x16x32_bf16 v[60:63], v[48:51], v[132:135], v[60:63]
    s_cmp_lg_u32 s32, 0
    s_cbranch_scc1 L_h_nopz
    s_setprio 3
L_h_nopz:
    s_mov_b32 exec_lo, -1
    s_mov_b32 exec_hi, 0
    s_nop 4
    ds_write_b128 v14, v[60:63] offset:0
    s_mov_b64 exec, 1
    ds_add_u32 v10, v11
    s_mov_b64 exec, -1
    s_cbranch_scc0 L_h_w0
    s_cmp_lg_u32 s32, 1
    s_cbranch_scc1 L_h_bar1
    s_cmp_ge_u32 s2, 8
    s_cbranch_scc1 L_h_bar1
    v_lshlrev_b32 v15, 4, v2
    s_mul_i32 s54, s2, 3072
    s_add_u32 s54, s54, 65536
    s_lshl_b32 s55, s2, 12
    s_add_u32 s55, s55, 90112
    v_lshrrev_b32 v13, 2, v2
    v_lshlrev_b32 v13, 8, v13
    v_and_b32 v14, 48, v15
    v_add3_u32 v13, s55, v13, v14
    v_add_u32 v15, s54, v15
    v_lshlrev_b32 v14, 10, v2
    v_add_u32 v14, s34, v14
    global_store_dwordx4 v13, v[80:83], s[24:25] sc1
    s_mov_b32 exec_hi, 0
    global_store_dwordx2 v14, v[80:81], s[24:25] offset:0 sc1
    s_mov_b64 exec, 1
    v_mov_b32 v85, 64
    s_waitcnt vmcnt(0)
    global_atomic_add v85, v11, s[22:23]
    s_mov_b64 exec, -1
    s_branch L_h_bar1
L_h_w0:
    s_mov_b32 s61, 0
L_h_pollq:
    ds_read_b32 v80, v10
    s_waitcnt lgkmcnt(0)
    v_readfirstlane_b32 s54, v80
    s_add_u32 s61, s61, 1
    s_nop 2
    s_cmp_ge_u32 s54, 4
    s_cbranch_scc1 L_h_pollqx
    s_sleep 1
    s_cmp_lt_u32 s61, 262144
    s_cbranch_scc1 L_h_pollq
L_h_pollqx:
    s_mov_b32 exec_hi, 0
    ds_read_b128 v[16:19], v15 offset:0
    ds_read_b128 v[20:23], v15 offset:512
    ds_read_b128 v[24:27], v15 offset:1024
    ds_read_b128 v[28:31], v15 offset:1536
    v_not_b32 v136, v136
    v_not_b32 v137, v137
    v_not_b32 v138, v138
    v_not_b32 v139, v139
    s_mov_b32 s58, 0
    s_mov_b32 s59, 0
    s_mov_b32 s60, 0
    s_waitcnt lgkmcnt(0)
    v_add_f32 v16, v16, v20
    v_add_f32 v24, v24, v28
    v_add_f32 v17, v17, v21
    v_add_f32 v25, v25, v29
    v_add_f32 v18, v18, v22
    v_add_f32 v26, v26, v30
    v_add_f32 v19, v19, v23
    v_add_f32 v27, v27, v31
    v_add_f32 v16, v16, v24
    v_add_f32 v17, v17, v25
    v_add_f32 v18, v18, v26
    v_add_f32 v19, v19, v27
    v_bfi_b32 v80, 1, v136, v16
    v_bfi_b32 v81, 1, v137, v17
    v_bfi_b32 v82, 1, v138, v18
    v_bfi_b32 v83, 1, v139, v19
    global_store_dwordx4 v36, v[80:83], s[24:25] sc1
    s_mov_b32 s61, 0
    v_mov_b32 v12, 64
    v_lshlrev_b32 v13, 10, v2
    v_xor_b32 v13, s34, v13
    s_sleep 40
L_h_pollx:
    global_load_dwordx4 v[20:23], v37, s[24:25] sc1
    global_load_dwordx4 v[24:27], v38, s[24:25] sc1
    global_load_dwordx4 v[28:31], v39, s[24:25] sc1
    s_add_u32 s61, s61, 1
    s_waitcnt vmcnt(2)
    v_xor_b32 v152, v20, v140
    v_xor_b32 v153, v21, v141
    v_xor_b32 v154, v22, v142
    v_xor_b32 v155, v23, v143
    v_and_b32 v152, v152, v153
    v_and_b32 v154, v154, v155
    v_and_or_b32 v152, v152, v154, s58
    s_waitcnt vmcnt(1)
    v_xor_b32 v156, v24, v144
    v_xor_b32 v157, v25, v145
    v_xor_b32 v158, v26, v146
    v_xor_b32 v159, v27, v147
    v_and_b32 v156, v156, v157
    v_and_b32 v158, v158, v159
    v_and_or_b32 v156, v156, v158, s59
    s_waitcnt vmcnt(0)
    v_xor_b32 v160, v28, v148
    v_xor_b32 v161, v29, v149
    v_xor_b32 v162, v30, v150
    v_xor_b32 v163, v31, v151
    v_and_b32 v160, v160, v161
    v_and_b32 v162, v162, v163
    v_and_or_b32 v160, v160, v162, s60
    v_and_b32 v152, v152, v156
    v_and_b32 v160, 1, v160
    v_and_b32 v152, v152, v160
    v_cmp_eq_u32 vcc, 0, v152
    s_cbranch_vccz L_h_gotq
    s_sleep 8
    s_cmp_lt_u32 s61, 6
    s_cbranch_scc1 L_h_pollx
    s_mov_b64 exec, 1
    global_load_dword v152, v12, s[22:23] sc1
    s_waitcnt vmcnt(0)
    v_readfirstlane_b32 s54, v152
    s_mov_b32 exec_lo, 15
    s_nop 2
    s_cmp_lt_u32 s54, 8
    s_cbranch_scc1 L_h_nofl
    global_load_dword v152, v13, s[24:25] offset:4 sc1
    s_waitcnt vmcnt(0)
    v_cmp_ne_u32 vcc, 0, v152
    s_nop 3
    s_bfe_u32 s58, vcc_lo, 65537
    s_bfe_u32 s59, vcc_lo, 65538
    s_bfe_u32 s60, vcc_lo, 65539
L_h_nofl:
    s_mov_b32 exec_lo, -1
    s_sleep 32
    s_cmp_lt_u32 s61, 16384
    s_cbranch_scc1 L_h_pollx
L_h_gotq:
    v_and_b32 v16, -2, v16
    v_and_b32 v17, -2, v17
    v_and_b32 v18, -2, v18
    v_and_b32 v19, -2, v19
    v_and_b32 v20, -2, v20
    v_and_b32 v21, -2, v21
    v_and_b32 v22, -2, v22
    v_and_b32 v23, -2, v23
    v_and_b32 v24, -2, v24
    v_and_b32 v25, -2, v25
    v_and_b32 v26, -2, v26
    v_and_b32 v27, -2, v27
    v_and_b32 v28, -2, v28
    v_and_b32 v29, -2, v29
    v_and_b32 v30, -2, v30
    v_and_b32 v31, -2, v31
    v_add_f32 v16, v16, v20
    v_add_f32 v24, v24, v28
    v_add_f32 v17, v17, v21
    v_add_f32 v25, v25, v29
    v_add_f32 v18, v18, v22
    v_add_f32 v26, v26, v30
    v_add_f32 v19, v19, v23
    v_add_f32 v27, v27, v31
    v_add_f32 v16, v16, v24
    v_add_f32 v17, v17, v25
    v_add_f32 v18, v18, v26
    v_add_f32 v19, v19, v27
    v_lshlrev_b32 v14, 3, v2
    v_cvt_pk_bf16_f32 v80, v16, v17
    v_cvt_pk_bf16_f32 v81, v18, v19
    ds_write_b64 v14, v[80:81] offset:14848
    s_mov_b64 exec, -1
L_h_bar1:
    s_waitcnt lgkmcnt(0)
    v_lshrrev_b32 v5, 3, v2
    v_mul_u32_u24 v5, 7, v5
    v_and_b32 v6, 7, v2
    v_min_u32 v6, 6, v6
    v_add_u32 v5, v5, v6
    v_mul_u32_u24 v61, 3, v5
    v_and_b32 v62, 1, v5
    v_lshlrev_b32 v1, 1, v61
    v_and_b32 v1, -4, v1
    v_min_u32 v1, 0x138, v1
    v_cmp_eq_u32 s[62:63], 1, v62
    s_mov_b32 s57, 0x07060302
    s_mov_b32 s58, 0x05040100
    v_mov_b32 v60, s58
    v_mov_b32 v6, s57
    s_mul_i32 s53, s30, 163840
    s_mul_i32 s54, s32, 320
    s_add_u32 s53, s53, s54
    v_cndmask_b32_e64 v60, v60, v6, s[62:63]
    buffer_load_dwordx2 v[16:17], v1, s[44:47], s53 offen offset:0 nt
    buffer_load_dwordx2 v[18:19], v1, s[44:47], s53 offen offset:1280 nt
    buffer_load_dwordx2 v[20:21], v1, s[44:47], s53 offen offset:2560 nt
    buffer_load_dwordx2 v[22:23], v1, s[44:47], s53 offen offset:3840 nt
    s_add_u32 s53, s53, 5120
    buffer_load_dwordx2 v[24:25], v1, s[44:47], s53 offen offset:0 nt
    buffer_load_dwordx2 v[26:27], v1, s[44:47], s53 offen offset:1280 nt
    buffer_load_dwordx2 v[28:29], v1, s[44:47], s53 offen offset:2560 nt
    s_barrier
    s_setprio 0
    s_waitcnt vmcnt(6)
    buffer_load_dwordx2 v[30:31], v1, s[44:47], s53 offen offset:3840 nt
    s_add_u32 s53, s53, 5120
    s_waitcnt vmcnt(6)
    v_cndmask_b32_e64 v56, v16, v17, s[62:63]
    v_cndmask_b32_e64 v57, v18, v19, s[62:63]
    v_perm_b32 v64, v18, v16, s57
    v_perm_b32 v66, v19, v17, s58
    v_perm_b32 v68, v57, v56, v60
    s_waitcnt vmcnt(6)
    buffer_load_dwordx2 v[16:17], v1, s[44:47], s53 offen offset:0 nt
    s_waitcnt vmcnt(6)
    buffer_load_dwordx2 v[18:19], v1, s[44:47], s53 offen offset:1280 nt
    s_waitcnt vmcnt(6)
    v_cndmask_b32_e64 v56, v20, v21, s[62:63]
    v_cndmask_b32_e64 v57, v22, v23, s[62:63]
    v_perm_b32 v65, v22, v20, s57
    v_perm_b32 v67, v23, v21, s58
    v_perm_b32 v69, v57, v56, v60
    s_waitcnt vmcnt(6)
    buffer_load_dwordx2 v[20:21], v1, s[44:47], s53 offen offset:2560 nt
    s_waitcnt vmcnt(6)
    buffer_load_dwordx2 v[22:23], v1, s[44:47], s53 offen offset:3840 nt
    s_add_u32 s53, s53, 5120
    s_waitcnt vmcnt(6)
    v_cndmask_b32_e64 v56, v24, v25, s[62:63]
    v_cndmask_b32_e64 v57, v26, v27, s[62:63]
    v_perm_b32 v70, v26, v24, s57
    v_perm_b32 v72, v27, v25, s58
    v_perm_b32 v74, v57, v56, v60
    s_waitcnt vmcnt(6)
    buffer_load_dwordx2 v[24:25], v1, s[44:47], s53 offen offset:0 nt
    s_waitcnt vmcnt(6)
    buffer_load_dwordx2 v[26:27], v1, s[44:47], s53 offen offset:1280 nt
    s_waitcnt vmcnt(6)
    v_cndmask_b32_e64 v56, v28, v29, s[62:63]
    v_cndmask_b32_e64 v57, v30, v31, s[62:63]
    v_perm_b32 v71, v30, v28, s57
    v_perm_b32 v73, v31, v29, s58
    v_perm_b32 v75, v57, v56, v60
    s_waitcnt vmcnt(6)
    buffer_load_dwordx2 v[28:29], v1, s[44:47], s53 offen offset:2560 nt
    s_waitcnt vmcnt(6)
    buffer_load_dwordx2 v[30:31], v1, s[44:47], s53 offen offset:3840 nt
    s_add_u32 s53, s53, 5120
    s_waitcnt vmcnt(6)
    v_cndmask_b32_e64 v56, v16, v17, s[62:63]
    v_cndmask_b32_e64 v57, v18, v19, s[62:63]
    v_perm_b32 v76, v18, v16, s57
    v_perm_b32 v78, v19, v17, s58
    v_perm_b32 v80, v57, v56, v60
    s_waitcnt vmcnt(6)
    buffer_load_dwordx2 v[16:17], v1, s[44:47], s53 offen offset:0 nt
    s_waitcnt vmcnt(6)
    buffer_load_dwordx2 v[18:19], v1, s[44:47], s53 offen offset:1280 nt
    s_waitcnt vmcnt(6)
    v_cndmask_b32_e64 v56, v20, v21, s[62:63]
    v_cndmask_b32_e64 v57, v22, v23, s[62:63]
    v_perm_b32 v77, v22, v20, s57
    v_perm_b32 v79, v23, v21, s58
    v_perm_b32 v81, v57, v56, v60
    s_waitcnt vmcnt(6)
    buffer_load_dwordx2 v[20:21], v1, s[44:47], s53 offen offset:2560 nt
    s_waitcnt vmcnt(6)
    buffer_load_dwordx2 v[22:23], v1, s[44:47], s53 offen offset:3840 nt
    s_add_u32 s53, s53, 5120
    s_waitcnt vmcnt(6)
    v_cndmask_b32_e64 v56, v24, v25, s[62:63]
    v_cndmask_b32_e64 v57, v26, v27, s[62:63]
    v_perm_b32 v82, v26, v24, s57
    v_perm_b32 v84, v27, v25, s58
    v_perm_b32 v86, v57, v56, v60
    s_waitcnt vmcnt(6)
    buffer_load_dwordx2 v[24:25], v1, s[44:47], s53 offen offset:0 nt
    s_waitcnt vmcnt(6)
    buffer_load_dwordx2 v[26:27], v1, s[44:47], s53 offen offset:1280 nt
    s_waitcnt vmcnt(6)
    v_cndmask_b32_e64 v56, v28, v29, s[62:63]
    v_cndmask_b32_e64 v57, v30, v31, s[62:63]
    v_perm_b32 v83, v30, v28, s57
    v_perm_b32 v85, v31, v29, s58
    v_perm_b32 v87, v57, v56, v60
    s_waitcnt vmcnt(6)
    buffer_load_dwordx2 v[28:29], v1, s[44:47], s53 offen offset:2560 nt
    s_waitcnt vmcnt(6)
    buffer_load_dwordx2 v[30:31], v1, s[44:47], s53 offen offset:3840 nt
    s_add_u32 s53, s53, 5120
    s_waitcnt vmcnt(6)
    v_cndmask_b32_e64 v56, v16, v17, s[62:63]
    v_cndmask_b32_e64 v57, v18, v19, s[62:63]
    v_perm_b32 v88, v18, v16, s57
    v_perm_b32 v90, v19, v17, s58
    v_perm_b32 v92, v57, v56, v60
    s_waitcnt vmcnt(6)
    buffer_load_dwordx2 v[16:17], v1, s[44:47], s53 offen offset:0 nt
    s_waitcnt vmcnt(6)
    buffer_load_dwordx2 v[18:19], v1, s[44:47], s53 offen offset:1280 nt
    s_waitcnt vmcnt(6)
    v_cndmask_b32_e64 v56, v20, v21, s[62:63]
    v_cndmask_b32_e64 v57, v22, v23, s[62:63]
    v_perm_b32 v89, v22, v20, s57
    v_perm_b32 v91, v23, v21, s58
    v_perm_b32 v93, v57, v56, v60
    s_waitcnt vmcnt(6)
    buffer_load_dwordx2 v[20:21], v1, s[44:47], s53 offen offset:2560 nt
    s_waitcnt vmcnt(6)
    buffer_load_dwordx2 v[22:23], v1, s[44:47], s53 offen offset:3840 nt
    s_add_u32 s53, s53, 5120
    s_waitcnt vmcnt(6)
    v_cndmask_b32_e64 v56, v24, v25, s[62:63]
    v_cndmask_b32_e64 v57, v26, v27, s[62:63]
    v_perm_b32 v94, v26, v24, s57
    v_perm_b32 v96, v27, v25, s58
    v_perm_b32 v98, v57, v56, v60
    s_waitcnt vmcnt(6)
    buffer_load_dwordx2 v[24:25], v1, s[44:47], s53 offen offset:0 nt
    s_waitcnt vmcnt(6)
    buffer_load_dwordx2 v[26:27], v1, s[44:47], s53 offen offset:1280 nt
    s_waitcnt vmcnt(6)
    v_cndmask_b32_e64 v56, v28, v29, s[62:63]
    v_cndmask_b32_e64 v57, v30, v31, s[62:63]
    v_perm_b32 v95, v30, v28, s57
    v_perm_b32 v97, v31, v29, s58
    v_perm_b32 v99, v57, v56, v60
    s_waitcnt vmcnt(6)
    buffer_load_dwordx2 v[28:29], v1, s[44:47], s53 offen offset:2560 nt
    s_waitcnt vmcnt(6)
    buffer_load_dwordx2 v[30:31], v1, s[44:47], s53 offen offset:3840 nt
    s_add_u32 s53, s53, 5120
    s_waitcnt vmcnt(6)
    v_cndmask_b32_e64 v56, v16, v17, s[62:63]
    v_cndmask_b32_e64 v57, v18, v19, s[62:63]
    v_perm_b32 v100, v18, v16, s57
    v_perm_b32 v102, v19, v17, s58
    v_perm_b32 v104, v57, v56, v60
    s_waitcnt vmcnt(6)
    buffer_load_dwordx2 v[16:17], v1, s[44:47], s53 offen offset:0 nt
    s_waitcnt vmcnt(6)
    buffer_load_dwordx2 v[18:19], v1, s[44:47], s53 offen offset:1280 nt
    s_waitcnt vmcnt(6)
    v_cndmask_b32_e64 v56, v20, v21, s[62:63]
    v_cndmask_b32_e64 v57, v22, v23, s[62:63]
    v_perm_b32 v101, v22, v20, s57
    v_perm_b32 v103, v23, v21, s58
    v_perm_b32 v105, v57, v56, v60
    s_waitcnt vmcnt(6)
    buffer_load_dwordx2 v[20:21], v1, s[44:47], s53 offen offset:2560 nt
    s_waitcnt vmcnt(6)
    buffer_load_dwordx2 v[22:23], v1, s[44:47], s53 offen offset:3840 nt
    s_add_u32 s53, s53, 5120
    s_waitcnt vmcnt(6)
    v_cndmask_b32_e64 v56, v24, v25, s[62:63]
    v_cndmask_b32_e64 v57, v26, v27, s[62:63]
    v_perm_b32 v106, v26, v24, s57
    v_perm_b32 v108, v27, v25, s58
    v_perm_b32 v110, v57, v56, v60
    s_waitcnt vmcnt(6)
    buffer_load_dwordx2 v[24:25], v1, s[44:47], s53 offen offset:0 nt
    s_waitcnt vmcnt(6)
    buffer_load_dwordx2 v[26:27], v1, s[44:47], s53 offen offset:1280 nt
    s_waitcnt vmcnt(6)
    v_cndmask_b32_e64 v56, v28, v29, s[62:63]
    v_cndmask_b32_e64 v57, v30, v31, s[62:63]
    v_perm_b32 v107, v30, v28, s57
    v_perm_b32 v109, v31, v29, s58
    v_perm_b32 v111, v57, v56, v60
    s_waitcnt vmcnt(6)
    buffer_load_dwordx2 v[28:29], v1, s[44:47], s53 offen offset:2560 nt
    s_waitcnt vmcnt(6)
    buffer_load_dwordx2 v[30:31], v1, s[44:47], s53 offen offset:3840 nt
    s_add_u32 s53, s53, 5120
    s_waitcnt vmcnt(6)
    v_cndmask_b32_e64 v56, v16, v17, s[62:63]
    v_cndmask_b32_e64 v57, v18, v19, s[62:63]
    v_perm_b32 v112, v18, v16, s57
    v_perm_b32 v114, v19, v17, s58
    v_perm_b32 v116, v57, v56, v60
    s_waitcnt vmcnt(6)
    buffer_load_dwordx2 v[16:17], v1, s[44:47], s53 offen offset:0 nt
    s_waitcnt vmcnt(6)
    buffer_load_dwordx2 v[18:19], v1, s[44:47], s53 offen offset:1280 nt
    s_waitcnt vmcnt(6)
    v_cndmask_b32_e64 v56, v20, v21, s[62:63]
    v_cndmask_b32_e64 v57, v22, v23, s[62:63]
    v_perm_b32 v113, v22, v20, s57
    v_perm_b32 v115, v23, v21, s58
    v_perm_b32 v117, v57, v56, v60
    s_waitcnt vmcnt(6)
    buffer_load_dwordx2 v[20:21], v1, s[44:47], s53 offen offset:2560 nt
    s_waitcnt vmcnt(6)
    buffer_load_dwordx2 v[22:23], v1, s[44:47], s53 offen offset:3840 nt
    s_add_u32 s53, s53, 5120
    s_waitcnt vmcnt(6)
    v_cndmask_b32_e64 v56, v24, v25, s[62:63]
    v_cndmask_b32_e64 v57, v26, v27, s[62:63]
    v_perm_b32 v118, v26, v24, s57
    v_perm_b32 v120, v27, v25, s58
    v_perm_b32 v122, v57, v56, v60
    s_waitcnt vmcnt(6)
    buffer_load_dwordx2 v[24:25], v1, s[44:47], s53 offen offset:0 nt
    s_waitcnt vmcnt(6)
    buffer_load_dwordx2 v[26:27], v1, s[44:47], s53 offen offset:1280 nt
    s_waitcnt vmcnt(6)
    v_cndmask_b32_e64 v56, v28, v29, s[62:63]
    v_cndmask_b32_e64 v57, v30, v31, s[62:63]
    v_perm_b32 v119, v30, v28, s57
    v_perm_b32 v121, v31, v29, s58
    v_perm_b32 v123, v57, v56, v60
    s_waitcnt vmcnt(6)
    buffer_load_dwordx2 v[28:29], v1, s[44:47], s53 offen offset:2560 nt
    s_waitcnt vmcnt(6)
    buffer_load_dwordx2 v[30:31], v1, s[44:47], s53 offen offset:3840 nt
    s_add_u32 s53, s53, 5120
    s_waitcnt vmcnt(6)
    v_cndmask_b32_e64 v56, v16, v17, s[62:63]
    v_cndmask_b32_e64 v57, v18, v19, s[62:63]
    v_perm_b32 v124, v18, v16, s57
    v_perm_b32 v126, v19, v17, s58
    v_perm_b32 v128, v57, v56, v60
    s_waitcnt vmcnt(6)
    buffer_load_dwordx2 v[16:17], v1, s[44:47], s53 offen offset:0 nt
    s_waitcnt vmcnt(6)
    buffer_load_dwordx2 v[18:19], v1, s[44:47], s53 offen offset:1280 nt
    s_waitcnt vmcnt(6)
    v_cndmask_b32_e64 v56, v20, v21, s[62:63]
    v_cndmask_b32_e64 v57, v22, v23, s[62:63]
    v_perm_b32 v125, v22, v20, s57
    v_perm_b32 v127, v23, v21, s58
    v_perm_b32 v129, v57, v56, v60
    s_waitcnt vmcnt(6)
    buffer_load_dwordx2 v[20:21], v1, s[44:47], s53 offen offset:2560 nt
    s_waitcnt vmcnt(6)
    buffer_load_dwordx2 v[22:23], v1, s[44:47], s53 offen offset:3840 nt
    s_add_u32 s53, s53, 5120
    s_waitcnt vmcnt(6)
    v_cndmask_b32_e64 v56, v24, v25, s[62:63]
    v_cndmask_b32_e64 v57, v26, v27, s[62:63]
    v_perm_b32 v130, v26, v24, s57
    v_perm_b32 v132, v27, v25, s58
    v_perm_b32 v134, v57, v56, v60
    s_waitcnt vmcnt(6)
    buffer_load_dwordx2 v[24:25], v1, s[44:47], s53 offen offset:0 nt
    s_waitcnt vmcnt(6)
    buffer_load_dwordx2 v[26:27], v1, s[44:47], s53 offen offset:1280 nt
    s_waitcnt vmcnt(6)
    v_cndmask_b32_e64 v56, v28, v29, s[62:63]
    v_cndmask_b32_e64 v57, v30, v31, s[62:63]
    v_perm_b32 v131, v30, v28, s57
    v_perm_b32 v133, v31, v29, s58
    v_perm_b32 v135, v57, v56, v60
    s_waitcnt vmcnt(6)
    buffer_load_dwordx2 v[28:29], v1, s[44:47], s53 offen offset:2560 nt
    s_waitcnt vmcnt(6)
    buffer_load_dwordx2 v[30:31], v1, s[44:47], s53 offen offset:3840 nt
    s_add_u32 s53, s53, 5120
    s_waitcnt vmcnt(6)
    v_cndmask_b32_e64 v56, v16, v17, s[62:63]
    v_cndmask_b32_e64 v57, v18, v19, s[62:63]
    v_perm_b32 v136, v18, v16, s57
    v_perm_b32 v138, v19, v17, s58
    v_perm_b32 v140, v57, v56, v60
    s_waitcnt vmcnt(6)
    buffer_load_dwordx2 v[16:17], v1, s[44:47], s53 offen offset:0 nt
    s_waitcnt vmcnt(6)
    buffer_load_dwordx2 v[18:19], v1, s[44:47], s53 offen offset:1280 nt
    s_waitcnt vmcnt(6)
    v_cndmask_b32_e64 v56, v20, v21, s[62:63]
    v_cndmask_b32_e64 v57, v22, v23, s[62:63]
    v_perm_b32 v137, v22, v20, s57
    v_perm_b32 v139, v23, v21, s58
    v_perm_b32 v141, v57, v56, v60
    s_waitcnt vmcnt(6)
    buffer_load_dwordx2 v[20:21], v1, s[44:47], s53 offen offset:2560 nt
    s_waitcnt vmcnt(6)
    buffer_load_dwordx2 v[22:23], v1, s[44:47], s53 offen offset:3840 nt
    s_add_u32 s53, s53, 5120
    s_waitcnt vmcnt(6)
    v_cndmask_b32_e64 v56, v24, v25, s[62:63]
    v_cndmask_b32_e64 v57, v26, v27, s[62:63]
    v_perm_b32 v142, v26, v24, s57
    v_perm_b32 v144, v27, v25, s58
    v_perm_b32 v146, v57, v56, v60
    s_waitcnt vmcnt(6)
    buffer_load_dwordx2 v[24:25], v1, s[44:47], s53 offen offset:0 nt
    s_waitcnt vmcnt(6)
    buffer_load_dwordx2 v[26:27], v1, s[44:47], s53 offen offset:1280 nt
    s_waitcnt vmcnt(6)
    v_cndmask_b32_e64 v56, v28, v29, s[62:63]
    v_cndmask_b32_e64 v57, v30, v31, s[62:63]
    v_perm_b32 v143, v30, v28, s57
    v_perm_b32 v145, v31, v29, s58
    v_perm_b32 v147, v57, v56, v60
    s_waitcnt vmcnt(6)
    buffer_load_dwordx2 v[28:29], v1, s[44:47], s53 offen offset:2560 nt
    s_waitcnt vmcnt(6)
    buffer_load_dwordx2 v[30:31], v1, s[44:47], s53 offen offset:3840 nt
    s_add_u32 s53, s53, 5120
    s_waitcnt vmcnt(6)
    v_cndmask_b32_e64 v56, v16, v17, s[62:63]
    v_cndmask_b32_e64 v57, v18, v19, s[62:63]
    v_perm_b32 v148, v18, v16, s57
    v_perm_b32 v150, v19, v17, s58
    v_perm_b32 v152, v57, v56, v60
    s_waitcnt vmcnt(6)
    buffer_load_dwordx2 v[16:17], v1, s[44:47], s53 offen offset:0 nt
    s_waitcnt vmcnt(6)
    buffer_load_dwordx2 v[18:19], v1, s[44:47], s53 offen offset:1280 nt
    s_waitcnt vmcnt(6)
    v_cndmask_b32_e64 v56, v20, v21, s[62:63]
    v_cndmask_b32_e64 v57, v22, v23, s[62:63]
    v_perm_b32 v149, v22, v20, s57
    v_perm_b32 v151, v23, v21, s58
    v_perm_b32 v153, v57, v56, v60
    s_waitcnt vmcnt(6)
    buffer_load_dwordx2 v[20:21], v1, s[44:47], s53 offen offset:2560 nt
    s_waitcnt vmcnt(6)
    buffer_load_dwordx2 v[22:23], v1, s[44:47], s53 offen offset:3840 nt
    s_add_u32 s53, s53, 5120
    s_waitcnt vmcnt(6)
    v_cndmask_b32_e64 v56, v24, v25, s[62:63]
    v_cndmask_b32_e64 v57, v26, v27, s[62:63]
    v_perm_b32 v154, v26, v24, s57
    v_perm_b32 v156, v27, v25, s58
    v_perm_b32 v158, v57, v56, v60
    s_waitcnt vmcnt(6)
    buffer_load_dwordx2 v[24:25], v1, s[44:47], s53 offen offset:0 nt
    s_waitcnt vmcnt(6)
    buffer_load_dwordx2 v[26:27], v1, s[44:47], s53 offen offset:1280 nt
    s_waitcnt vmcnt(6)
    v_cndmask_b32_e64 v56, v28, v29, s[62:63]
    v_cndmask_b32_e64 v57, v30, v31, s[62:63]
    v_perm_b32 v155, v30, v28, s57
    v_perm_b32 v157, v31, v29, s58
    v_perm_b32 v159, v57, v56, v60
    s_waitcnt vmcnt(6)
    buffer_load_dwordx2 v[28:29], v1, s[44:47], s53 offen offset:2560 nt
    s_waitcnt vmcnt(6)
    buffer_load_dwordx2 v[30:31], v1, s[44:47], s53 offen offset:3840 nt
    s_add_u32 s53, s53, 5120
    s_waitcnt vmcnt(6)
    v_cndmask_b32_e64 v56, v16, v17, s[62:63]
    v_cndmask_b32_e64 v57, v18, v19, s[62:63]
    v_perm_b32 v160, v18, v16, s57
    v_perm_b32 v162, v19, v17, s58
    v_perm_b32 v164, v57, v56, v60
    s_waitcnt vmcnt(6)
    buffer_load_dwordx2 v[16:17], v1, s[44:47], s53 offen offset:0 nt
    s_waitcnt vmcnt(6)
    buffer_load_dwordx2 v[18:19], v1, s[44:47], s53 offen offset:1280 nt
    s_waitcnt vmcnt(6)
    v_cndmask_b32_e64 v56, v20, v21, s[62:63]
    v_cndmask_b32_e64 v57, v22, v23, s[62:63]
    v_perm_b32 v161, v22, v20, s57
    v_perm_b32 v163, v23, v21, s58
    v_perm_b32 v165, v57, v56, v60
    s_waitcnt vmcnt(6)
    buffer_load_dwordx2 v[20:21], v1, s[44:47], s53 offen offset:2560 nt
    s_waitcnt vmcnt(6)
    buffer_load_dwordx2 v[22:23], v1, s[44:47], s53 offen offset:3840 nt
    s_add_u32 s53, s53, 5120
    s_waitcnt vmcnt(6)
    v_cndmask_b32_e64 v56, v24, v25, s[62:63]
    v_cndmask_b32_e64 v57, v26, v27, s[62:63]
    v_perm_b32 v166, v26, v24, s57
    v_perm_b32 v168, v27, v25, s58
    v_perm_b32 v170, v57, v56, v60
    s_waitcnt vmcnt(6)
    buffer_load_dwordx2 v[24:25], v1, s[44:47], s53 offen offset:0 nt
    s_waitcnt vmcnt(6)
    buffer_load_dwordx2 v[26:27], v1, s[44:47], s53 offen offset:1280 nt
    s_waitcnt vmcnt(6)
    v_cndmask_b32_e64 v56, v28, v29, s[62:63]
    v_cndmask_b32_e64 v57, v30, v31, s[62:63]
    v_perm_b32 v167, v30, v28, s57
    v_perm_b32 v169, v31, v29, s58
    v_perm_b32 v171, v57, v56, v60
    s_waitcnt vmcnt(6)
    buffer_load_dwordx2 v[28:29], v1, s[44:47], s53 offen offset:2560 nt
    s_waitcnt vmcnt(6)
    buffer_load_dwordx2 v[30:31], v1, s[44:47], s53 offen offset:3840 nt
    s_add_u32 s53, s53, 5120
    s_waitcnt vmcnt(6)
    v_cndmask_b32_e64 v56, v16, v17, s[62:63]
    v_cndmask_b32_e64 v57, v18, v19, s[62:63]
    v_perm_b32 v172, v18, v16, s57
    v_perm_b32 v174, v19, v17, s58
    v_perm_b32 v176, v57, v56, v60
    s_waitcnt vmcnt(6)
    buffer_load_dwordx2 v[16:17], v1, s[44:47], s53 offen offset:0 nt
    s_waitcnt vmcnt(6)
    buffer_load_dwordx2 v[18:19], v1, s[44:47], s53 offen offset:1280 nt
    s_waitcnt vmcnt(6)
    v_cndmask_b32_e64 v56, v20, v21, s[62:63]
    v_cndmask_b32_e64 v57, v22, v23, s[62:63]
    v_perm_b32 v173, v22, v20, s57
    v_perm_b32 v175, v23, v21, s58
    v_perm_b32 v177, v57, v56, v60
    s_waitcnt vmcnt(6)
    buffer_load_dwordx2 v[20:21], v1, s[44:47], s53 offen offset:2560 nt
    s_waitcnt vmcnt(6)
    buffer_load_dwordx2 v[22:23], v1, s[44:47], s53 offen offset:3840 nt
    s_add_u32 s53, s53, 5120
    s_waitcnt vmcnt(6)
    v_cndmask_b32_e64 v56, v24, v25, s[62:63]
    v_cndmask_b32_e64 v57, v26, v27, s[62:63]
    v_perm_b32 v178, v26, v24, s57
    v_perm_b32 v180, v27, v25, s58
    v_perm_b32 v182, v57, v56, v60
    s_waitcnt vmcnt(6)
    buffer_load_dwordx2 v[24:25], v1, s[44:47], s53 offen offset:0 nt
    s_waitcnt vmcnt(6)
    buffer_load_dwordx2 v[26:27], v1, s[44:47], s53 offen offset:1280 nt
    s_waitcnt vmcnt(6)
    v_cndmask_b32_e64 v56, v28, v29, s[62:63]
    v_cndmask_b32_e64 v57, v30, v31, s[62:63]
    v_perm_b32 v179, v30, v28, s57
    v_perm_b32 v181, v31, v29, s58
    v_perm_b32 v183, v57, v56, v60
    s_waitcnt vmcnt(6)
    buffer_load_dwordx2 v[28:29], v1, s[44:47], s53 offen offset:2560 nt
    s_waitcnt vmcnt(6)
    buffer_load_dwordx2 v[30:31], v1, s[44:47], s53 offen offset:3840 nt
    s_add_u32 s53, s53, 5120
    s_waitcnt vmcnt(6)
    v_cndmask_b32_e64 v56, v16, v17, s[62:63]
    v_cndmask_b32_e64 v57, v18, v19, s[62:63]
    v_perm_b32 v184, v18, v16, s57
    v_perm_b32 v186, v19, v17, s58
    v_perm_b32 v188, v57, v56, v60
    s_waitcnt vmcnt(6)
    buffer_load_dwordx2 v[16:17], v1, s[44:47], s53 offen offset:0 nt
    s_waitcnt vmcnt(6)
    buffer_load_dwordx2 v[18:19], v1, s[44:47], s53 offen offset:1280 nt
    s_waitcnt vmcnt(6)
    v_cndmask_b32_e64 v56, v20, v21, s[62:63]
    v_cndmask_b32_e64 v57, v22, v23, s[62:63]
    v_perm_b32 v185, v22, v20, s57
    v_perm_b32 v187, v23, v21, s58
    v_perm_b32 v189, v57, v56, v60
    s_waitcnt vmcnt(6)
    buffer_load_dwordx2 v[20:21], v1, s[44:47], s53 offen offset:2560 nt
    s_waitcnt vmcnt(6)
    buffer_load_dwordx2 v[22:23], v1, s[44:47], s53 offen offset:3840 nt
    s_add_u32 s53, s53, 5120
    s_waitcnt vmcnt(6)
    v_cndmask_b32_e64 v56, v24, v25, s[62:63]
    v_cndmask_b32_e64 v57, v26, v27, s[62:63]
    v_perm_b32 v190, v26, v24, s57
    v_perm_b32 v192, v27, v25, s58
    v_perm_b32 v194, v57, v56, v60
    s_waitcnt vmcnt(6)
    buffer_load_dwordx2 v[24:25], v1, s[44:47], s53 offen offset:0 nt
    s_waitcnt vmcnt(6)
    buffer_load_dwordx2 v[26:27], v1, s[44:47], s53 offen offset:1280 nt
    s_waitcnt vmcnt(6)
    v_cndmask_b32_e64 v56, v28, v29, s[62:63]
    v_cndmask_b32_e64 v57, v30, v31, s[62:63]
    v_perm_b32 v191, v30, v28, s57
    v_perm_b32 v193, v31, v29, s58
    v_perm_b32 v195, v57, v56, v60
    s_waitcnt vmcnt(6)
    buffer_load_dwordx2 v[28:29], v1, s[44:47], s53 offen offset:2560 nt
    s_waitcnt vmcnt(6)
    buffer_load_dwordx2 v[30:31], v1, s[44:47], s53 offen offset:3840 nt
    s_add_u32 s53, s53, 5120
    s_waitcnt vmcnt(6)
    v_cndmask_b32_e64 v56, v16, v17, s[62:63]
    v_cndmask_b32_e64 v57, v18, v19, s[62:63]
    v_perm_b32 v196, v18, v16, s57
    v_perm_b32 v198, v19, v17, s58
    v_perm_b32 v200, v57, v56, v60
    s_waitcnt vmcnt(6)
    buffer_load_dwordx2 v[16:17], v1, s[44:47], s53 offen offset:0 nt
    s_waitcnt vmcnt(6)
    buffer_load_dwordx2 v[18:19], v1, s[44:47], s53 offen offset:1280 nt
    s_waitcnt vmcnt(6)
    v_cndmask_b32_e64 v56, v20, v21, s[62:63]
    v_cndmask_b32_e64 v57, v22, v23, s[62:63]
    v_perm_b32 v197, v22, v20, s57
    v_perm_b32 v199, v23, v21, s58
    v_perm_b32 v201, v57, v56, v60
    s_waitcnt vmcnt(6)
    buffer_load_dwordx2 v[20:21], v1, s[44:47], s53 offen offset:2560 nt
    s_waitcnt vmcnt(6)
    buffer_load_dwordx2 v[22:23], v1, s[44:47], s53 offen offset:3840 nt
    s_add_u32 s53, s53, 5120
    s_waitcnt vmcnt(6)
    v_cndmask_b32_e64 v56, v24, v25, s[62:63]
    v_cndmask_b32_e64 v57, v26, v27, s[62:63]
    v_perm_b32 v202, v26, v24, s57
    v_perm_b32 v204, v27, v25, s58
    v_perm_b32 v206, v57, v56, v60
    s_waitcnt vmcnt(6)
    buffer_load_dwordx2 v[24:25], v1, s[44:47], s53 offen offset:0 nt
    s_waitcnt vmcnt(6)
    buffer_load_dwordx2 v[26:27], v1, s[44:47], s53 offen offset:1280 nt
    s_waitcnt vmcnt(6)
    v_cndmask_b32_e64 v56, v28, v29, s[62:63]
    v_cndmask_b32_e64 v57, v30, v31, s[62:63]
    v_perm_b32 v203, v30, v28, s57
    v_perm_b32 v205, v31, v29, s58
    v_perm_b32 v207, v57, v56, v60
    s_waitcnt vmcnt(6)
    buffer_load_dwordx2 v[28:29], v1, s[44:47], s53 offen offset:2560 nt
    s_waitcnt vmcnt(6)
    buffer_load_dwordx2 v[30:31], v1, s[44:47], s53 offen offset:3840 nt
    s_add_u32 s53, s53, 5120
    s_waitcnt vmcnt(6)
    v_cndmask_b32_e64 v56, v16, v17, s[62:63]
    v_cndmask_b32_e64 v57, v18, v19, s[62:63]
    v_perm_b32 v208, v18, v16, s57
    v_perm_b32 v210, v19, v17, s58
    v_perm_b32 v212, v57, v56, v60
    s_waitcnt vmcnt(6)
    buffer_load_dwordx2 v[16:17], v1, s[44:47], s53 offen offset:0 nt
    s_waitcnt vmcnt(6)
    buffer_load_dwordx2 v[18:19], v1, s[44:47], s53 offen offset:1280 nt
    s_waitcnt vmcnt(6)
    v_cndmask_b32_e64 v56, v20, v21, s[62:63]
    v_cndmask_b32_e64 v57, v22, v23, s[62:63]
    v_perm_b32 v209, v22, v20, s57
    v_perm_b32 v211, v23, v21, s58
    v_perm_b32 v213, v57, v56, v60
    s_waitcnt vmcnt(6)
    buffer_load_dwordx2 v[20:21], v1, s[44:47], s53 offen offset:2560 nt
    s_waitcnt vmcnt(6)
    buffer_load_dwordx2 v[22:23], v1, s[44:47], s53 offen offset:3840 nt
    s_add_u32 s53, s53, 5120
    s_waitcnt vmcnt(6)
    v_cndmask_b32_e64 v56, v24, v25, s[62:63]
    v_cndmask_b32_e64 v57, v26, v27, s[62:63]
    v_perm_b32 v214, v26, v24, s57
    v_perm_b32 v216, v27, v25, s58
    v_perm_b32 v218, v57, v56, v60
    s_waitcnt vmcnt(6)
    buffer_load_dwordx2 v[24:25], v1, s[44:47], s53 offen offset:0 nt
    s_waitcnt vmcnt(6)
    buffer_load_dwordx2 v[26:27], v1, s[44:47], s53 offen offset:1280 nt
    s_waitcnt vmcnt(6)
    v_cndmask_b32_e64 v56, v28, v29, s[62:63]
    v_cndmask_b32_e64 v57, v30, v31, s[62:63]
    v_perm_b32 v215, v30, v28, s57
    v_perm_b32 v217, v31, v29, s58
    v_perm_b32 v219, v57, v56, v60
    s_waitcnt vmcnt(6)
    buffer_load_dwordx2 v[28:29], v1, s[44:47], s53 offen offset:2560 nt
    s_waitcnt vmcnt(6)
    buffer_load_dwordx2 v[30:31], v1, s[44:47], s53 offen offset:3840 nt
    s_add_u32 s53, s53, 5120
    s_waitcnt vmcnt(6)
    v_cndmask_b32_e64 v56, v16, v17, s[62:63]
    v_cndmask_b32_e64 v57, v18, v19, s[62:63]
    v_perm_b32 v220, v18, v16, s57
    v_perm_b32 v222, v19, v17, s58
    v_perm_b32 v224, v57, v56, v60
    s_waitcnt vmcnt(6)
    buffer_load_dwordx2 v[16:17], v1, s[44:47], s53 offen offset:0 nt
    s_waitcnt vmcnt(6)
    buffer_load_dwordx2 v[18:19], v1, s[44:47], s53 offen offset:1280 nt
    s_waitcnt vmcnt(6)
    v_cndmask_b32_e64 v56, v20, v21, s[62:63]
    v_cndmask_b32_e64 v57, v22, v23, s[62:63]
    v_perm_b32 v221, v22, v20, s57
    v_perm_b32 v223, v23, v21, s58
    v_perm_b32 v225, v57, v56, v60
    s_waitcnt vmcnt(6)
    buffer_load_dwordx2 v[20:21], v1, s[44:47], s53 offen offset:2560 nt
    s_waitcnt vmcnt(6)
    buffer_load_dwordx2 v[22:23], v1, s[44:47], s53 offen offset:3840 nt
    s_add_u32 s53, s53, 5120
    s_waitcnt vmcnt(6)
    v_cndmask_b32_e64 v56, v24, v25, s[62:63]
    v_cndmask_b32_e64 v57, v26, v27, s[62:63]
    v_perm_b32 v226, v26, v24, s57
    v_perm_b32 v228, v27, v25, s58
    v_perm_b32 v230, v57, v56, v60
    s_waitcnt vmcnt(6)
    buffer_load_dwordx2 v[24:25], v1, s[44:47], s53 offen offset:0 nt
    s_waitcnt vmcnt(6)
    buffer_load_dwordx2 v[26:27], v1, s[44:47], s53 offen offset:1280 nt
    s_waitcnt vmcnt(6)
    v_cndmask_b32_e64 v56, v28, v29, s[62:63]
    v_cndmask_b32_e64 v57, v30, v31, s[62:63]
    v_perm_b32 v227, v30, v28, s57
    v_perm_b32 v229, v31, v29, s58
    v_perm_b32 v231, v57, v56, v60
    s_waitcnt vmcnt(6)
    buffer_load_dwordx2 v[28:29], v1, s[44:47], s53 offen offset:2560 nt
    s_waitcnt vmcnt(6)
    buffer_load_dwordx2 v[30:31], v1, s[44:47], s53 offen offset:3840 nt
    s_add_u32 s53, s53, 5120
    s_waitcnt vmcnt(6)
    v_cndmask_b32_e64 v56, v16, v17, s[62:63]
    v_cndmask_b32_e64 v57, v18, v19, s[62:63]
    v_perm_b32 v232, v18, v16, s57
    v_perm_b32 v234, v19, v17, s58
    v_perm_b32 v236, v57, v56, v60
    s_waitcnt vmcnt(6)
    buffer_load_dwordx2 v[16:17], v1, s[44:47], s53 offen offset:0 nt
    s_waitcnt vmcnt(6)
    buffer_load_dwordx2 v[18:19], v1, s[44:47], s53 offen offset:1280 nt
    s_waitcnt vmcnt(6)
    v_cndmask_b32_e64 v56, v20, v21, s[62:63]
    v_cndmask_b32_e64 v57, v22, v23, s[62:63]
    v_perm_b32 v233, v22, v20, s57
    v_perm_b32 v235, v23, v21, s58
    v_perm_b32 v237, v57, v56, v60
    s_waitcnt vmcnt(6)
    buffer_load_dwordx2 v[20:21], v1, s[44:47], s53 offen offset:2560 nt
    s_waitcnt vmcnt(6)
    buffer_load_dwordx2 v[22:23], v1, s[44:47], s53 offen offset:3840 nt
    s_add_u32 s53, s53, 5120
    s_waitcnt vmcnt(6)
    v_cndmask_b32_e64 v56, v24, v25, s[62:63]
    v_cndmask_b32_e64 v57, v26, v27, s[62:63]
    v_perm_b32 v238, v26, v24, s57
    v_perm_b32 v240, v27, v25, s58
    v_perm_b32 v242, v57, v56, v60
    s_waitcnt vmcnt(6)
    buffer_load_dwordx2 v[24:25], v1, s[44:47], s53 offen offset:0 nt
    s_waitcnt vmcnt(6)
    buffer_load_dwordx2 v[26:27], v1, s[44:47], s53 offen offset:1280 nt
    s_waitcnt vmcnt(6)
    v_cndmask_b32_e64 v56, v28, v29, s[62:63]
    v_cndmask_b32_e64 v57, v30, v31, s[62:63]
    v_perm_b32 v239, v30, v28, s57
    v_perm_b32 v241, v31, v29, s58
    v_perm_b32 v243, v57, v56, v60
    s_waitcnt vmcnt(6)
    buffer_load_dwordx2 v[28:29], v1, s[44:47], s53 offen offset:2560 nt
    s_waitcnt vmcnt(6)
    buffer_load_dwordx2 v[30:31], v1, s[44:47], s53 offen offset:3840 nt
    s_waitcnt vmcnt(6)
    v_cndmask_b32_e64 v56, v16, v17, s[62:63]
    v_cndmask_b32_e64 v57, v18, v19, s[62:63]
    v_perm_b32 v244, v18, v16, s57
    v_perm_b32 v246, v19, v17, s58
    v_perm_b32 v248, v57, v56, v60
    s_waitcnt vmcnt(4)
    v_cndmask_b32_e64 v56, v20, v21, s[62:63]
    v_cndmask_b32_e64 v57, v22, v23, s[62:63]
    v_perm_b32 v245, v22, v20, s57
    v_perm_b32 v247, v23, v21, s58
    v_perm_b32 v249, v57, v56, v60
    s_waitcnt vmcnt(2)
    v_cndmask_b32_e64 v56, v24, v25, s[62:63]
    v_cndmask_b32_e64 v57, v26, v27, s[62:63]
    v_perm_b32 v250, v26, v24, s57
    v_perm_b32 v252, v27, v25, s58
    v_perm_b32 v254, v57, v56, v60
    s_waitcnt vmcnt(0)
    v_cndmask_b32_e64 v56, v28, v29, s[62:63]
    v_cndmask_b32_e64 v57, v30, v31, s[62:63]
    v_perm_b32 v251, v30, v28, s57
    v_perm_b32 v253, v31, v29, s58
    v_perm_b32 v255, v57, v56, v60
    s_cmp_lg_u32 s32, 0
    s_cbranch_scc1 L_h_bar2
    v_and_b32 v5, 7, v2
    v_and_b32 v6, 12, v2
    v_lshl_or_b32 v5, v6, 4, v5
    v_and_b32 v6, 6, v2
    v_lshl_or_b32 v5, v6, 2, v5
    v_and_b32 v6, 1, v2
    v_lshl_or_b32 v5, v6, 5, v5
    v_lshlrev_b32 v6, 7, v5
    v_xor_b32 v5, s34, v6
    s_mov_b64 exec, 1
    v_mov_b32 v12, 64
    s_mov_b32 s61, 0
L_h_pollz:
    global_load_dword v55, v12, s[22:23] sc1
    s_waitcnt vmcnt(0)
    v_readfirstlane_b32 s60, v55
    s_add_u32 s61, s61, 1
    s_nop 2
    s_cmp_ge_u32 s60, 8
    s_cbranch_scc1 L_h_zok
    s_sleep 32
    s_cmp_lt_u32 s61, 16384
    s_cbranch_scc1 L_h_pollz
L_h_zok:
    v_mov_b32 v14, 2080
    s_mov_b32 s61, 0
L_h_poll1:
    ds_read_b32 v40, v14
    s_waitcnt lgkmcnt(0)
    v_readfirstlane_b32 s54, v40
    s_add_u32 s61, s61, 1
    s_nop 2
    s_and_b32 s54, s54, 0xff
    s_cmp_ge_u32 s54, 4
    s_cbranch_scc1 L_h_poll1x
    s_sleep 16
    s_cmp_lt_u32 s61, 16384
    s_cbranch_scc1 L_h_poll1
L_h_poll1x:
    s_mov_b32 exec_lo, 0xfffe
    global_load_dword v6, v5, s[24:25] offset:4 sc1
    s_mov_b64 exec, 1
    v_mov_b32 v14, 2048
    ds_read_b128 v[40:43], v14
    ds_read_b128 v[44:47], v14 offset:16
    s_mov_b32 s55, 0x3fb8aa3b
    s_waitcnt lgkmcnt(0)
    v_max3_f32 v48, v40, v42, v44
    v_max_f32 v48, v48, v46
    v_sub_f32 v50, v40, v48
    v_sub_f32 v51, v42, v48
    v_sub_f32 v52, v44, v48
    v_sub_f32 v53, v46, v48
    v_mul_f32 v50, s55, v50
    v_mul_f32 v51, s55, v51
    v_mul_f32 v52, s55, v52
    v_mul_f32 v53, s55, v53
    v_exp_f32 v50, v50
    v_exp_f32 v51, v51
    v_exp_f32 v52, v52
    v_exp_f32 v53, v53
    s_nop 0
    v_mul_f32 v49, v50, v41
    v_fmac_f32 v49, v51, v43
    v_fmac_f32 v49, v52, v45
    v_fmac_f32 v49, v53, v47
    s_andn2_b32 s54, s34, 0xc00
    v_mov_b32 v13, s34
    v_mov_b32 v15, s54
    global_store_dwordx2 v13, v[48:49], s[24:25] offset:0 sc1
    s_mov_b32 exec_lo, 0xfffe
    s_mov_b32 s57, 0
    s_waitcnt vmcnt(1)
    v_cmp_ne_u32 vcc, 0, v6
    s_mov_b64 exec, 1
    v_mov_b32 v14, 2080
    s_nop 1
    s_bcnt1_i32_b32 s54, vcc_lo
    s_cmp_ge_u32 s54, 3
    s_cselect_b32 s57, 0x55555555, s57
    s_cmp_ge_u32 s54, 6
    s_cselect_b32 s57, 0x6db6db6d, s57
    s_cmp_ge_u32 s54, 9
    s_cselect_b32 s57, 0x77777777, s57
    s_cmp_ge_u32 s54, 12
    s_cselect_b32 s57, 0x7f7f7f7f, s57
    s_cmp_ge_u32 s54, 13
    s_cselect_b32 s57, 0xffffffff, s57
    v_mov_b32 v6, s57
    ds_write_b32 v14, v6 offset:8
    v_mov_b32 v14, 2080
    s_mov_b32 s61, 0
L_h_poll1b:
    ds_read_b32 v54, v14
    s_waitcnt lgkmcnt(0)
    v_readfirstlane_b32 s54, v54
    s_add_u32 s61, s61, 1
    s_nop 2
    s_cmp_ge_u32 s54, 0x100
    s_cbranch_scc1 L_h_poll1bx
    s_sleep 16
    s_cmp_lt_u32 s61, 16384
    s_cbranch_scc1 L_h_poll1b
L_h_poll1bx:
    s_mov_b32 s61, 0
L_h_poll2:
    global_load_dwordx2 v[16:17], v15, s[24:25] offset:0 sc1
    global_load_dwordx2 v[18:19], v15, s[24:25] offset:1024 sc1
    global_load_dwordx2 v[20:21], v15, s[24:25] offset:2048 sc1
    global_load_dwordx2 v[22:23], v15, s[24:25] offset:3072 sc1
    s_waitcnt vmcnt(0)
    v_min_u32 v24, v17, v19
    v_min3_u32 v24, v24, v21, v23
    s_add_u32 s61, s61, 1
    v_readfirstlane_b32 s59, v24
    s_nop 3
    s_cmp_lg_u32 s59, 0
    s_cbranch_scc1 L_h_got
    s_sleep 32
    s_cmp_lt_u32 s61, 16384
    s_cbranch_scc1 L_h_poll2
L_h_got:
    v_max3_f32 v24, v16, v18, v20
    v_max_f32 v24, v24, v22
    v_sub_f32 v26, v16, v24
    v_sub_f32 v27, v18, v24
    v_sub_f32 v28, v20, v24
    v_sub_f32 v29, v22, v24
    v_mul_f32 v26, s55, v26
    v_mul_f32 v27, s55, v27
    v_mul_f32 v28, s55, v28
    v_mul_f32 v29, s55, v29
    v_exp_f32 v26, v26
    v_exp_f32 v27, v27
    v_exp_f32 v28, v28
    v_exp_f32 v29, v29
    s_nop 0
    v_mul_f32 v25, v26, v17
    v_fmac_f32 v25, v27, v19
    v_fmac_f32 v25, v28, v21
    v_fmac_f32 v25, v29, v23
    v_rcp_f32 v25, v25
    v_sub_f32 v28, v40, v24
    v_sub_f32 v29, v42, v24
    v_sub_f32 v30, v44, v24
    v_sub_f32 v31, v46, v24
    v_mul_f32 v28, s55, v28
    v_mul_f32 v29, s55, v29
    v_mul_f32 v30, s55, v30
    v_mul_f32 v31, s55, v31
    v_exp_f32 v28, v28
    v_exp_f32 v29, v29
    v_exp_f32 v30, v30
    v_exp_f32 v31, v31
    s_nop 0
    v_mul_f32 v28, v28, v25
    v_mul_f32 v29, v29, v25
    v_mul_f32 v30, v30, v25
    v_mul_f32 v31, v31, v25
    v_mov_b32 v14, 2096
    ds_write_b128 v14, v[28:31]
    s_mov_b64 exec, -1
    s_waitcnt lgkmcnt(0)
L_h_bar2:
    v_mov_b32 v14, 2096
    v_lshlrev_b32 v15, 4, v2
    v_and_b32 v5, 7, v2
    v_cmp_eq_u32 s[58:59], 7, v5
    v_sub_u32 v6, v61, v62
    v_add_u32 v8, 1, v6
    v_add_u32 v9, 2, v6
    v_lshl_add_u32 v10, v62, 1, v61
    v_mov_b32 v7, 159
    v_cmp_eq_u32 vcc, 0xa1, v10
    s_mul_i32 s54, s32, 320
    v_cndmask_b32 v10, v10, v7, vcc
    v_cmp_gt_u32 vcc, v7, v8
    s_andn2_b64 s[86:87], vcc, s[58:59]
    s_or_b64 s[92:93], s[58:59], s[86:87]
    v_lshl_add_u32 v8, v8, 1, s54
    v_cmp_gt_u32 vcc, v7, v9
    s_andn2_b64 s[88:89], vcc, s[58:59]
    s_or_b64 s[94:95], s[58:59], s[88:89]
    v_lshl_add_u32 v9, v9, 1, s54
    v_cmp_ge_u32 vcc, v7, v10
    s_andn2_b64 s[90:91], vcc, s[58:59]
    s_or_b64 s[96:97], s[58:59], s[90:91]
    v_lshl_add_u32 v10, v10, 1, s54
    v_lshrrev_b32 v12, 4, v0
    v_lshlrev_b32 v12, 8, v12
    v_lshl_add_u32 v12, v3, 2, v12
    s_lshl_b32 s54, s31, 14
    s_add_u32 s54, s54, 90112
    v_add_u32 v12, s54, v12
    s_add_u32 s40, s24, 4096
    s_addc_u32 s41, s25, 0
    s_add_u32 s42, s24, 8192
    s_addc_u32 s43, s25, 0
    s_mov_b32 s48, s20
    s_mov_b32 s49, s21
    s_mov_b32 s50, 2560
    s_mov_b32 s51, 0x20000
    s_mul_i32 s56, s31, 1280
    s_mov_b32 s55, 0x43000000
    s_barrier
    ds_read_b128 v[36:39], v15 offset:2304
    ds_read_b128 v[40:43], v14
    s_waitcnt lgkmcnt(1)
    v_mfma_f32_4x4x4_16b_bf16 v[44:47], v[36:37], v[64:65], 0 cbsz:4 abid:0
    v_mfma_f32_4x4x4_16b_bf16 v[48:51], v[36:37], v[66:67], 0 cbsz:4 abid:0
    v_mfma_f32_4x4x4_16b_bf16 v[52:55], v[36:37], v[68:69], 0 cbsz:4 abid:0
    v_mfma_f32_4x4x4_16b_bf16 v[44:47], v[36:37], v[70:71], v[44:47] cbsz:4 abid:1
    v_mfma_f32_4x4x4_16b_bf16 v[48:51], v[36:37], v[72:73], v[48:51] cbsz:4 abid:1
    v_mfma_f32_4x4x4_16b_bf16 v[52:55], v[36:37], v[74:75], v[52:55] cbsz:4 abid:1
    v_mfma_f32_4x4x4_16b_bf16 v[44:47], v[36:37], v[76:77], v[44:47] cbsz:4 abid:2
    v_mfma_f32_4x4x4_16b_bf16 v[48:51], v[36:37], v[78:79], v[48:51] cbsz:4 abid:2
    v_mfma_f32_4x4x4_16b_bf16 v[52:55], v[36:37], v[80:81], v[52:55] cbsz:4 abid:2
    v_mfma_f32_4x4x4_16b_bf16 v[44:47], v[36:37], v[82:83], v[44:47] cbsz:4 abid:3
    v_mfma_f32_4x4x4_16b_bf16 v[48:51], v[36:37], v[84:85], v[48:51] cbsz:4 abid:3
    v_mfma_f32_4x4x4_16b_bf16 v[52:55], v[36:37], v[86:87], v[52:55] cbsz:4 abid:3
    v_mfma_f32_4x4x4_16b_bf16 v[44:47], v[36:37], v[88:89], v[44:47] cbsz:4 abid:4
    v_mfma_f32_4x4x4_16b_bf16 v[48:51], v[36:37], v[90:91], v[48:51] cbsz:4 abid:4
    v_mfma_f32_4x4x4_16b_bf16 v[52:55], v[36:37], v[92:93], v[52:55] cbsz:4 abid:4
    v_mfma_f32_4x4x4_16b_bf16 v[44:47], v[36:37], v[94:95], v[44:47] cbsz:4 abid:5
    v_mfma_f32_4x4x4_16b_bf16 v[48:51], v[36:37], v[96:97], v[48:51] cbsz:4 abid:5
    v_mfma_f32_4x4x4_16b_bf16 v[52:55], v[36:37], v[98:99], v[52:55] cbsz:4 abid:5
    v_mfma_f32_4x4x4_16b_bf16 v[44:47], v[36:37], v[100:101], v[44:47] cbsz:4 abid:6
    v_mfma_f32_4x4x4_16b_bf16 v[48:51], v[36:37], v[102:103], v[48:51] cbsz:4 abid:6
    v_mfma_f32_4x4x4_16b_bf16 v[52:55], v[36:37], v[104:105], v[52:55] cbsz:4 abid:6
    v_mfma_f32_4x4x4_16b_bf16 v[44:47], v[36:37], v[106:107], v[44:47] cbsz:4 abid:7
    v_mfma_f32_4x4x4_16b_bf16 v[48:51], v[36:37], v[108:109], v[48:51] cbsz:4 abid:7
    v_mfma_f32_4x4x4_16b_bf16 v[52:55], v[36:37], v[110:111], v[52:55] cbsz:4 abid:7
    v_mfma_f32_4x4x4_16b_bf16 v[44:47], v[36:37], v[112:113], v[44:47] cbsz:4 abid:8
    v_mfma_f32_4x4x4_16b_bf16 v[48:51], v[36:37], v[114:115], v[48:51] cbsz:4 abid:8
    v_mfma_f32_4x4x4_16b_bf16 v[52:55], v[36:37], v[116:117], v[52:55] cbsz:4 abid:8
    v_mfma_f32_4x4x4_16b_bf16 v[44:47], v[36:37], v[118:119], v[44:47] cbsz:4 abid:9
    v_mfma_f32_4x4x4_16b_bf16 v[48:51], v[36:37], v[120:121], v[48:51] cbsz:4 abid:9
    v_mfma_f32_4x4x4_16b_bf16 v[52:55], v[36:37], v[122:123], v[52:55] cbsz:4 abid:9
    v_mfma_f32_4x4x4_16b_bf16 v[44:47], v[36:37], v[124:125], v[44:47] cbsz:4 abid:10
    v_mfma_f32_4x4x4_16b_bf16 v[48:51], v[36:37], v[126:127], v[48:51] cbsz:4 abid:10
    v_mfma_f32_4x4x4_16b_bf16 v[52:55], v[36:37], v[128:129], v[52:55] cbsz:4 abid:10
    v_mfma_f32_4x4x4_16b_bf16 v[44:47], v[36:37], v[130:131], v[44:47] cbsz:4 abid:11
    v_mfma_f32_4x4x4_16b_bf16 v[48:51], v[36:37], v[132:133], v[48:51] cbsz:4 abid:11
    v_mfma_f32_4x4x4_16b_bf16 v[52:55], v[36:37], v[134:135], v[52:55] cbsz:4 abid:11
    v_mfma_f32_4x4x4_16b_bf16 v[44:47], v[36:37], v[136:137], v[44:47] cbsz:4 abid:12
    v_mfma_f32_4x4x4_16b_bf16 v[48:51], v[36:37], v[138:139], v[48:51] cbsz:4 abid:12
    v_mfma_f32_4x4x4_16b_bf16 v[52:55], v[36:37], v[140:141], v[52:55] cbsz:4 abid:12
    v_mfma_f32_4x4x4_16b_bf16 v[44:47], v[36:37], v[142:143], v[44:47] cbsz:4 abid:13
    v_mfma_f32_4x4x4_16b_bf16 v[48:51], v[36:37], v[144:145], v[48:51] cbsz:4 abid:13
    v_mfma_f32_4x4x4_16b_bf16 v[52:55], v[36:37], v[146:147], v[52:55] cbsz:4 abid:13
    v_mfma_f32_4x4x4_16b_bf16 v[44:47], v[36:37], v[148:149], v[44:47] cbsz:4 abid:14
    v_mfma_f32_4x4x4_16b_bf16 v[48:51], v[36:37], v[150:151], v[48:51] cbsz:4 abid:14
    v_mfma_f32_4x4x4_16b_bf16 v[52:55], v[36:37], v[152:153], v[52:55] cbsz:4 abid:14
    v_mfma_f32_4x4x4_16b_bf16 v[44:47], v[36:37], v[154:155], v[44:47] cbsz:4 abid:15
    v_mfma_f32_4x4x4_16b_bf16 v[48:51], v[36:37], v[156:157], v[48:51] cbsz:4 abid:15
    v_mfma_f32_4x4x4_16b_bf16 v[52:55], v[36:37], v[158:159], v[52:55] cbsz:4 abid:15
    v_mfma_f32_4x4x4_16b_bf16 v[44:47], v[38:39], v[160:161], v[44:47] cbsz:4 abid:0
    v_mfma_f32_4x4x4_16b_bf16 v[48:51], v[38:39], v[162:163], v[48:51] cbsz:4 abid:0
    v_mfma_f32_4x4x4_16b_bf16 v[52:55], v[38:39], v[164:165], v[52:55] cbsz:4 abid:0
    v_mfma_f32_4x4x4_16b_bf16 v[44:47], v[38:39], v[166:167], v[44:47] cbsz:4 abid:1
    v_mfma_f32_4x4x4_16b_bf16 v[48:51], v[38:39], v[168:169], v[48:51] cbsz:4 abid:1
    v_mfma_f32_4x4x4_16b_bf16 v[52:55], v[38:39], v[170:171], v[52:55] cbsz:4 abid:1
    v_mfma_f32_4x4x4_16b_bf16 v[44:47], v[38:39], v[172:173], v[44:47] cbsz:4 abid:2
    v_mfma_f32_4x4x4_16b_bf16 v[48:51], v[38:39], v[174:175], v[48:51] cbsz:4 abid:2
    v_mfma_f32_4x4x4_16b_bf16 v[52:55], v[38:39], v[176:177], v[52:55] cbsz:4 abid:2
    v_mfma_f32_4x4x4_16b_bf16 v[44:47], v[38:39], v[178:179], v[44:47] cbsz:4 abid:3
    v_mfma_f32_4x4x4_16b_bf16 v[48:51], v[38:39], v[180:181], v[48:51] cbsz:4 abid:3
    v_mfma_f32_4x4x4_16b_bf16 v[52:55], v[38:39], v[182:183], v[52:55] cbsz:4 abid:3
    v_mfma_f32_4x4x4_16b_bf16 v[44:47], v[38:39], v[184:185], v[44:47] cbsz:4 abid:4
    v_mfma_f32_4x4x4_16b_bf16 v[48:51], v[38:39], v[186:187], v[48:51] cbsz:4 abid:4
    v_mfma_f32_4x4x4_16b_bf16 v[52:55], v[38:39], v[188:189], v[52:55] cbsz:4 abid:4
    v_mfma_f32_4x4x4_16b_bf16 v[44:47], v[38:39], v[190:191], v[44:47] cbsz:4 abid:5
    v_mfma_f32_4x4x4_16b_bf16 v[48:51], v[38:39], v[192:193], v[48:51] cbsz:4 abid:5
    v_mfma_f32_4x4x4_16b_bf16 v[52:55], v[38:39], v[194:195], v[52:55] cbsz:4 abid:5
    v_mfma_f32_4x4x4_16b_bf16 v[44:47], v[38:39], v[196:197], v[44:47] cbsz:4 abid:6
    v_mfma_f32_4x4x4_16b_bf16 v[48:51], v[38:39], v[198:199], v[48:51] cbsz:4 abid:6
    v_mfma_f32_4x4x4_16b_bf16 v[52:55], v[38:39], v[200:201], v[52:55] cbsz:4 abid:6
    v_mfma_f32_4x4x4_16b_bf16 v[44:47], v[38:39], v[202:203], v[44:47] cbsz:4 abid:7
    v_mfma_f32_4x4x4_16b_bf16 v[48:51], v[38:39], v[204:205], v[48:51] cbsz:4 abid:7
    v_mfma_f32_4x4x4_16b_bf16 v[52:55], v[38:39], v[206:207], v[52:55] cbsz:4 abid:7
    v_mfma_f32_4x4x4_16b_bf16 v[44:47], v[38:39], v[208:209], v[44:47] cbsz:4 abid:8
    v_mfma_f32_4x4x4_16b_bf16 v[48:51], v[38:39], v[210:211], v[48:51] cbsz:4 abid:8
    v_mfma_f32_4x4x4_16b_bf16 v[52:55], v[38:39], v[212:213], v[52:55] cbsz:4 abid:8
    v_mfma_f32_4x4x4_16b_bf16 v[44:47], v[38:39], v[214:215], v[44:47] cbsz:4 abid:9
    v_mfma_f32_4x4x4_16b_bf16 v[48:51], v[38:39], v[216:217], v[48:51] cbsz:4 abid:9
    v_mfma_f32_4x4x4_16b_bf16 v[52:55], v[38:39], v[218:219], v[52:55] cbsz:4 abid:9
    v_mfma_f32_4x4x4_16b_bf16 v[44:47], v[38:39], v[220:221], v[44:47] cbsz:4 abid:10
    v_mfma_f32_4x4x4_16b_bf16 v[48:51], v[38:39], v[222:223], v[48:51] cbsz:4 abid:10
    v_mfma_f32_4x4x4_16b_bf16 v[52:55], v[38:39], v[224:225], v[52:55] cbsz:4 abid:10
    v_mfma_f32_4x4x4_16b_bf16 v[44:47], v[38:39], v[226:227], v[44:47] cbsz:4 abid:11
    v_mfma_f32_4x4x4_16b_bf16 v[48:51], v[38:39], v[228:229], v[48:51] cbsz:4 abid:11
    v_mfma_f32_4x4x4_16b_bf16 v[52:55], v[38:39], v[230:231], v[52:55] cbsz:4 abid:11
    v_mfma_f32_4x4x4_16b_bf16 v[44:47], v[38:39], v[232:233], v[44:47] cbsz:4 abid:12
    v_mfma_f32_4x4x4_16b_bf16 v[48:51], v[38:39], v[234:235], v[48:51] cbsz:4 abid:12
    v_mfma_f32_4x4x4_16b_bf16 v[52:55], v[38:39], v[236:237], v[52:55] cbsz:4 abid:12
    v_mfma_f32_4x4x4_16b_bf16 v[44:47], v[38:39], v[238:239], v[44:47] cbsz:4 abid:13
    v_mfma_f32_4x4x4_16b_bf16 v[48:51], v[38:39], v[240:241], v[48:51] cbsz:4 abid:13
    v_mfma_f32_4x4x4_16b_bf16 v[52:55], v[38:39], v[242:243], v[52:55] cbsz:4 abid:13
    v_mfma_f32_4x4x4_16b_bf16 v[44:47], v[38:39], v[244:245], v[44:47] cbsz:4 abid:14
    v_mfma_f32_4x4x4_16b_bf16 v[48:51], v[38:39], v[246:247], v[48:51] cbsz:4 abid:14
    v_mfma_f32_4x4x4_16b_bf16 v[52:55], v[38:39], v[248:249], v[52:55] cbsz:4 abid:14
    v_mfma_f32_4x4x4_16b_bf16 v[44:47], v[38:39], v[250:251], v[44:47] cbsz:4 abid:15
    v_mfma_f32_4x4x4_16b_bf16 v[48:51], v[38:39], v[252:253], v[48:51] cbsz:4 abid:15
    v_mfma_f32_4x4x4_16b_bf16 v[52:55], v[38:39], v[254:255], v[52:55] cbsz:4 abid:15
    s_waitcnt lgkmcnt(0)
    s_nop 1
    v_mul_f32 v16, v40, v44
    v_mul_f32 v24, v42, v46
    v_fmac_f32 v16, v41, v45
    v_fmac_f32 v24, v43, v47
    v_add_f32 v16, v16, v24
    v_cndmask_b32_e64 v16, v16, 1.0, s[58:59]
    s_mov_b64 exec, s[92:93]
    global_atomic_add_f32 v20, v12, v16, s[24:25] sc0
    s_mov_b64 exec, -1
    v_mul_f32 v17, v40, v48
    v_mul_f32 v25, v42, v50
    v_fmac_f32 v17, v41, v49
    v_fmac_f32 v25, v43, v51
    v_add_f32 v17, v17, v25
    v_cndmask_b32_e64 v17, v17, 1.0, s[58:59]
    s_mov_b64 exec, s[94:95]
    global_atomic_add_f32 v21, v12, v17, s[40:41] sc0
    s_mov_b64 exec, -1
    v_mul_f32 v18, v40, v52
    v_mul_f32 v26, v42, v54
    v_fmac_f32 v18, v41, v53
    v_fmac_f32 v26, v43, v55
    v_add_f32 v18, v18, v26
    v_cndmask_b32_e64 v18, v18, 1.0, s[58:59]
    s_mov_b64 exec, s[96:97]
    global_atomic_add_f32 v22, v12, v18, s[42:43] sc0
    s_mov_b64 exec, -1
    s_waitcnt vmcnt(0)
    v_add_f32 v16, v20, v16
    v_add_f32 v17, v21, v17
    v_add_f32 v18, v22, v18
    s_nop 0
    v_mov_b32_dpp v24, v16 row_newbcast:7 row_mask:0xf bank_mask:0x3
    v_mov_b32_dpp v24, v16 row_newbcast:15 row_mask:0xf bank_mask:0xc
    v_mov_b32_dpp v25, v17 row_newbcast:7 row_mask:0xf bank_mask:0x3
    v_mov_b32_dpp v25, v17 row_newbcast:15 row_mask:0xf bank_mask:0xc
    v_mov_b32_dpp v26, v18 row_newbcast:7 row_mask:0xf bank_mask:0x3
    v_mov_b32_dpp v26, v18 row_newbcast:15 row_mask:0xf bank_mask:0xc
    v_cvt_pk_bf16_f32 v16, v16, v16
    v_cvt_pk_bf16_f32 v17, v17, v17
    v_cvt_pk_bf16_f32 v18, v18, v18
    v_cmp_eq_f32 vcc, s55, v24
    s_and_b64 exec, vcc, s[86:87]
    buffer_store_short v16, v8, s[48:51], s56 offen
    s_mov_b64 exec, -1
    v_cmp_eq_f32 vcc, s55, v25
    s_and_b64 exec, vcc, s[88:89]
    buffer_store_short v17, v9, s[48:51], s56 offen
    s_mov_b64 exec, -1
    v_cmp_eq_f32 vcc, s55, v26
    s_and_b64 exec, vcc, s[90:91]
    buffer_store_short v18, v10, s[48:51], s56 offen
    s_endpgm
L_stream:
    s_sub_u32 s33, s32, 4
    s_lshl_b32 s52, s30, 21
    s_bfe_u32 s53, s28, 65536
    s_lshl_b32 s53, s53, 16
    s_add_u32 s52, s52, s53
    s_bfe_u32 s53, s28, 65537
    s_lshl_b32 s53, s53, 19
    s_add_u32 s52, s52, s53
    s_bfe_u32 s53, s33, 65536
    s_lshl_b32 s53, s53, 12
    s_add_u32 s52, s52, s53
    s_bfe_u32 s53, s33, 65537
    s_lshl_b32 s53, s53, 13
    s_add_u32 s52, s52, s53
    v_lshlrev_b32 v8, 4, v3
    v_and_b32 v9, 1, v4
    v_lshl_add_u32 v8, v9, 8, v8
    v_lshrrev_b32 v9, 1, v4
    v_lshl_add_u32 v8, v9, 9, v8
    v_add_u32 v9, 0x400, v8
    v_add_u32 v10, 0x4000, v8
    v_add_u32 v7, 0x4400, v8
    s_mov_b32 s53, 0
    s_mov_b32 s62, 0xcccccccc
    s_mov_b32 s63, 0xcccccccc
    s_mov_b32 s64, 0xaaaaaaaa
    s_mov_b32 s65, 0xaaaaaaaa
    s_mov_b32 s66, 0x3db504f3
    s_mov_b32 s67, 0x3fb8aa3b
    s_waitcnt lgkmcnt(0)
    s_mov_b32 s36, s10
    s_mov_b32 s37, s11
    s_mov_b32 s38, 0x4000000
    s_mov_b32 s39, 0x20000
    s_barrier
    s_add_u32 s54, s52, s53
    s_waitcnt vmcnt(5)
    buffer_load_dwordx4 v[64:67], v8, s[36:39], s54 offen nt
    s_waitcnt vmcnt(5)
    buffer_load_dwordx4 v[68:71], v9, s[36:39], s54 offen nt
    s_waitcnt vmcnt(5)
    buffer_load_dwordx4 v[72:75], v10, s[36:39], s54 offen nt
    s_waitcnt vmcnt(5)
    buffer_load_dwordx4 v[76:79], v7, s[36:39], s54 offen nt
    s_or_b32 s53, s53, 0xffe977ff
    s_add_u32 s53, s53, 1
    s_and_b32 s53, s53, 0x168800
    s_add_u32 s54, s52, s53
    s_waitcnt vmcnt(5)
    buffer_load_dwordx4 v[80:83], v8, s[36:39], s54 offen nt
    s_waitcnt vmcnt(5)
    buffer_load_dwordx4 v[84:87], v9, s[36:39], s54 offen nt
    s_waitcnt vmcnt(5)
    buffer_load_dwordx4 v[88:91], v10, s[36:39], s54 offen nt
    s_waitcnt vmcnt(5)
    buffer_load_dwordx4 v[92:95], v7, s[36:39], s54 offen nt
    s_or_b32 s53, s53, 0xffe977ff
    s_add_u32 s53, s53, 1
    s_and_b32 s53, s53, 0x168800
    s_add_u32 s54, s52, s53
    s_waitcnt vmcnt(5)
    buffer_load_dwordx4 v[96:99], v8, s[36:39], s54 offen nt
    s_waitcnt vmcnt(5)
    buffer_load_dwordx4 v[100:103], v9, s[36:39], s54 offen nt
    s_waitcnt vmcnt(5)
    buffer_load_dwordx4 v[104:107], v10, s[36:39], s54 offen nt
    s_waitcnt vmcnt(5)
    buffer_load_dwordx4 v[108:111], v7, s[36:39], s54 offen nt
    s_or_b32 s53, s53, 0xffe977ff
    s_add_u32 s53, s53, 1
    s_and_b32 s53, s53, 0x168800
    s_add_u32 s54, s52, s53
    s_waitcnt vmcnt(5)
    buffer_load_dwordx4 v[112:115], v8, s[36:39], s54 offen nt
    s_waitcnt vmcnt(5)
    buffer_load_dwordx4 v[116:119], v9, s[36:39], s54 offen nt
    s_waitcnt vmcnt(5)
    buffer_load_dwordx4 v[120:123], v10, s[36:39], s54 offen nt
    s_waitcnt vmcnt(5)
    buffer_load_dwordx4 v[124:127], v7, s[36:39], s54 offen nt
    s_or_b32 s53, s53, 0xffe977ff
    s_add_u32 s53, s53, 1
    s_and_b32 s53, s53, 0x168800
    s_add_u32 s54, s52, s53
    s_waitcnt vmcnt(5)
    buffer_load_dwordx4 v[128:131], v8, s[36:39], s54 offen nt
    s_waitcnt vmcnt(5)
    buffer_load_dwordx4 v[132:135], v9, s[36:39], s54 offen nt
    s_waitcnt vmcnt(5)
    buffer_load_dwordx4 v[136:139], v10, s[36:39], s54 offen nt
    s_waitcnt vmcnt(5)
    buffer_load_dwordx4 v[140:143], v7, s[36:39], s54 offen nt
    s_or_b32 s53, s53, 0xffe977ff
    s_add_u32 s53, s53, 1
    s_and_b32 s53, s53, 0x168800
    s_add_u32 s54, s52, s53
    s_waitcnt vmcnt(5)
    buffer_load_dwordx4 v[144:147], v8, s[36:39], s54 offen nt
    s_waitcnt vmcnt(5)
    buffer_load_dwordx4 v[148:151], v9, s[36:39], s54 offen nt
    s_waitcnt vmcnt(5)
    buffer_load_dwordx4 v[152:155], v10, s[36:39], s54 offen nt
    s_waitcnt vmcnt(5)
    buffer_load_dwordx4 v[156:159], v7, s[36:39], s54 offen nt
    s_or_b32 s53, s53, 0xffe977ff
    s_add_u32 s53, s53, 1
    s_and_b32 s53, s53, 0x168800
    s_add_u32 s54, s52, s53
    s_waitcnt vmcnt(5)
    buffer_load_dwordx4 v[160:163], v8, s[36:39], s54 offen nt
    s_waitcnt vmcnt(5)
    buffer_load_dwordx4 v[164:167], v9, s[36:39], s54 offen nt
    s_waitcnt vmcnt(5)
    buffer_load_dwordx4 v[168:171], v10, s[36:39], s54 offen nt
    s_waitcnt vmcnt(5)
    buffer_load_dwordx4 v[172:175], v7, s[36:39], s54 offen nt
    s_or_b32 s53, s53, 0xffe977ff
    s_add_u32 s53, s53, 1
    s_and_b32 s53, s53, 0x168800
    s_add_u32 s54, s52, s53
    s_waitcnt vmcnt(5)
    buffer_load_dwordx4 v[176:179], v8, s[36:39], s54 offen nt
    s_waitcnt vmcnt(5)
    buffer_load_dwordx4 v[180:183], v9, s[36:39], s54 offen nt
    s_waitcnt vmcnt(5)
    buffer_load_dwordx4 v[184:187], v10, s[36:39], s54 offen nt
    s_waitcnt vmcnt(5)
    buffer_load_dwordx4 v[188:191], v7, s[36:39], s54 offen nt
    s_or_b32 s53, s53, 0xffe977ff
    s_add_u32 s53, s53, 1
    s_and_b32 s53, s53, 0x168800
    v_lshlrev_b32 v13, 4, v3
    s_barrier
    ds_read_b128 v[52:55], v13 offset:14848
    s_waitcnt lgkmcnt(0)
    s_mov_b32 s55, 0
L_kloop:
    s_cmp_eq_u32 s55, 3
    s_cselect_b32 s36, s12, s36
    s_cselect_b32 s37, s13, s37
    s_waitcnt vmcnt(28)
    v_dot2_f32_bf16 v16, v64, v52, 0
    v_dot2_f32_bf16 v17, v68, v52, 0
    v_dot2_f32_bf16 v18, v72, v52, 0
    v_dot2_f32_bf16 v19, v76, v52, 0
    v_dot2_f32_bf16 v16, v65, v53, v16
    v_dot2_f32_bf16 v17, v69, v53, v17
    v_dot2_f32_bf16 v18, v73, v53, v18
    v_dot2_f32_bf16 v19, v77, v53, v19
    v_dot2_f32_bf16 v16, v66, v54, v16
    v_dot2_f32_bf16 v17, v70, v54, v17
    v_dot2_f32_bf16 v18, v74, v54, v18
    v_dot2_f32_bf16 v19, v78, v54, v19
    v_dot2_f32_bf16 v16, v67, v55, v16
    v_dot2_f32_bf16 v17, v71, v55, v17
    v_dot2_f32_bf16 v18, v75, v55, v18
    v_dot2_f32_bf16 v19, v79, v55, v19
    s_add_u32 s54, s52, s53
    s_waitcnt vmcnt(5)
    buffer_load_dwordx4 v[64:67], v8, s[36:39], s54 offen nt
    s_waitcnt vmcnt(5)
    buffer_load_dwordx4 v[68:71], v9, s[36:39], s54 offen nt
    s_waitcnt vmcnt(5)
    buffer_load_dwordx4 v[72:75], v10, s[36:39], s54 offen nt
    s_waitcnt vmcnt(5)
    buffer_load_dwordx4 v[76:79], v7, s[36:39], s54 offen nt
    s_or_b32 s53, s53, 0xffe977ff
    s_add_u32 s53, s53, 1
    s_and_b32 s53, s53, 0x168800
    s_waitcnt vmcnt(28)
    v_dot2_f32_bf16 v20, v80, v52, 0
    v_dot2_f32_bf16 v21, v84, v52, 0
    v_dot2_f32_bf16 v22, v88, v52, 0
    v_dot2_f32_bf16 v23, v92, v52, 0
    v_dot2_f32_bf16 v20, v81, v53, v20
    v_dot2_f32_bf16 v21, v85, v53, v21
    v_dot2_f32_bf16 v22, v89, v53, v22
    v_dot2_f32_bf16 v23, v93, v53, v23
    v_dot2_f32_bf16 v20, v82, v54, v20
    v_dot2_f32_bf16 v21, v86, v54, v21
    v_dot2_f32_bf16 v22, v90, v54, v22
    v_dot2_f32_bf16 v23, v94, v54, v23
    v_dot2_f32_bf16 v20, v83, v55, v20
    v_dot2_f32_bf16 v21, v87, v55, v21
    v_dot2_f32_bf16 v22, v91, v55, v22
    v_dot2_f32_bf16 v23, v95, v55, v23
    s_add_u32 s54, s52, s53
    s_waitcnt vmcnt(5)
    buffer_load_dwordx4 v[80:83], v8, s[36:39], s54 offen nt
    s_waitcnt vmcnt(5)
    buffer_load_dwordx4 v[84:87], v9, s[36:39], s54 offen nt
    s_waitcnt vmcnt(5)
    buffer_load_dwordx4 v[88:91], v10, s[36:39], s54 offen nt
    s_waitcnt vmcnt(5)
    buffer_load_dwordx4 v[92:95], v7, s[36:39], s54 offen nt
    s_or_b32 s53, s53, 0xffe977ff
    s_add_u32 s53, s53, 1
    s_and_b32 s53, s53, 0x168800
    s_waitcnt vmcnt(28)
    v_dot2_f32_bf16 v24, v96, v52, 0
    v_dot2_f32_bf16 v25, v100, v52, 0
    v_dot2_f32_bf16 v26, v104, v52, 0
    v_dot2_f32_bf16 v27, v108, v52, 0
    v_dot2_f32_bf16 v24, v97, v53, v24
    v_dot2_f32_bf16 v25, v101, v53, v25
    v_dot2_f32_bf16 v26, v105, v53, v26
    v_dot2_f32_bf16 v27, v109, v53, v27
    v_dot2_f32_bf16 v24, v98, v54, v24
    v_dot2_f32_bf16 v25, v102, v54, v25
    v_dot2_f32_bf16 v26, v106, v54, v26
    v_dot2_f32_bf16 v27, v110, v54, v27
    v_dot2_f32_bf16 v24, v99, v55, v24
    v_dot2_f32_bf16 v25, v103, v55, v25
    v_dot2_f32_bf16 v26, v107, v55, v26
    v_dot2_f32_bf16 v27, v111, v55, v27
    s_add_u32 s54, s52, s53
    s_waitcnt vmcnt(5)
    buffer_load_dwordx4 v[96:99], v8, s[36:39], s54 offen nt
    s_waitcnt vmcnt(5)
    buffer_load_dwordx4 v[100:103], v9, s[36:39], s54 offen nt
    s_waitcnt vmcnt(5)
    buffer_load_dwordx4 v[104:107], v10, s[36:39], s54 offen nt
    s_waitcnt vmcnt(5)
    buffer_load_dwordx4 v[108:111], v7, s[36:39], s54 offen nt
    s_or_b32 s53, s53, 0xffe977ff
    s_add_u32 s53, s53, 1
    s_and_b32 s53, s53, 0x168800
    s_waitcnt vmcnt(28)
    v_dot2_f32_bf16 v28, v112, v52, 0
    v_dot2_f32_bf16 v29, v116, v52, 0
    v_dot2_f32_bf16 v30, v120, v52, 0
    v_dot2_f32_bf16 v31, v124, v52, 0
    v_dot2_f32_bf16 v28, v113, v53, v28
    v_dot2_f32_bf16 v29, v117, v53, v29
    v_dot2_f32_bf16 v30, v121, v53, v30
    v_dot2_f32_bf16 v31, v125, v53, v31
    v_dot2_f32_bf16 v28, v114, v54, v28
    v_dot2_f32_bf16 v29, v118, v54, v29
    v_dot2_f32_bf16 v30, v122, v54, v30
    v_dot2_f32_bf16 v31, v126, v54, v31
    v_dot2_f32_bf16 v28, v115, v55, v28
    v_dot2_f32_bf16 v29, v119, v55, v29
    v_dot2_f32_bf16 v30, v123, v55, v30
    v_dot2_f32_bf16 v31, v127, v55, v31
    s_add_u32 s54, s52, s53
    s_waitcnt vmcnt(5)
    buffer_load_dwordx4 v[112:115], v8, s[36:39], s54 offen nt
    s_waitcnt vmcnt(5)
    buffer_load_dwordx4 v[116:119], v9, s[36:39], s54 offen nt
    s_waitcnt vmcnt(5)
    buffer_load_dwordx4 v[120:123], v10, s[36:39], s54 offen nt
    s_waitcnt vmcnt(5)
    buffer_load_dwordx4 v[124:127], v7, s[36:39], s54 offen nt
    s_or_b32 s53, s53, 0xffe977ff
    s_add_u32 s53, s53, 1
    s_and_b32 s53, s53, 0x168800
    v_add_f32_dpp v16, v16, v16 row_ror:8 row_mask:0xf bank_mask:0x3
    v_add_f32_dpp v17, v17, v17 row_ror:8 row_mask:0xf bank_mask:0x3
    v_add_f32_dpp v18, v18, v18 row_ror:8 row_mask:0xf bank_mask:0x3
    v_add_f32_dpp v19, v19, v19 row_ror:8 row_mask:0xf bank_mask:0x3
    v_add_f32_dpp v20, v20, v20 row_ror:8 row_mask:0xf bank_mask:0x3
    v_add_f32_dpp v21, v21, v21 row_ror:8 row_mask:0xf bank_mask:0x3
    v_add_f32_dpp v22, v22, v22 row_ror:8 row_mask:0xf bank_mask:0x3
    v_add_f32_dpp v23, v23, v23 row_ror:8 row_mask:0xf bank_mask:0x3
    v_add_f32_dpp v16, v24, v24 row_ror:8 row_mask:0xf bank_mask:0xc
    v_add_f32_dpp v17, v25, v25 row_ror:8 row_mask:0xf bank_mask:0xc
    v_add_f32_dpp v18, v26, v26 row_ror:8 row_mask:0xf bank_mask:0xc
    v_add_f32_dpp v19, v27, v27 row_ror:8 row_mask:0xf bank_mask:0xc
    v_add_f32_dpp v20, v28, v28 row_ror:8 row_mask:0xf bank_mask:0xc
    v_add_f32_dpp v21, v29, v29 row_ror:8 row_mask:0xf bank_mask:0xc
    v_add_f32_dpp v22, v30, v30 row_ror:8 row_mask:0xf bank_mask:0xc
    v_add_f32_dpp v23, v31, v31 row_ror:8 row_mask:0xf bank_mask:0xc
    v_add_f32_dpp v16, v16, v16 row_half_mirror row_mask:0xf bank_mask:0x5
    v_add_f32_dpp v17, v17, v17 row_half_mirror row_mask:0xf bank_mask:0x5
    v_add_f32_dpp v18, v18, v18 row_half_mirror row_mask:0xf bank_mask:0x5
    v_add_f32_dpp v19, v19, v19 row_half_mirror row_mask:0xf bank_mask:0x5
    s_nop 0
    v_add_f32_dpp v16, v20, v20 row_half_mirror row_mask:0xf bank_mask:0xa
    v_add_f32_dpp v17, v21, v21 row_half_mirror row_mask:0xf bank_mask:0xa
    v_add_f32_dpp v18, v22, v22 row_half_mirror row_mask:0xf bank_mask:0xa
    v_add_f32_dpp v19, v23, v23 row_half_mirror row_mask:0xf bank_mask:0xa
    s_nop 1
    v_add_f32_dpp v16, v16, v16 quad_perm:[2,3,0,1] row_mask:0xf bank_mask:0xf
    v_add_f32_dpp v17, v17, v17 quad_perm:[2,3,0,1] row_mask:0xf bank_mask:0xf
    v_add_f32_dpp v18, v18, v18 quad_perm:[2,3,0,1] row_mask:0xf bank_mask:0xf
    v_add_f32_dpp v19, v19, v19 quad_perm:[2,3,0,1] row_mask:0xf bank_mask:0xf
    v_cndmask_b32_e64 v16, v16, v18, s[62:63]
    v_cndmask_b32_e64 v17, v17, v19, s[62:63]
    s_nop 1
    v_add_f32_dpp v16, v16, v16 quad_perm:[1,0,3,2] row_mask:0xf bank_mask:0xf
    v_add_f32_dpp v17, v17, v17 quad_perm:[1,0,3,2] row_mask:0xf bank_mask:0xf
    v_cndmask_b32_e64 v16, v16, v17, s[64:65]
    v_cvt_pk_bf16_f32 v16, v16, v16
    v_and_b32 v16, 0xffff0000, v16
    v_mul_f32 v16, s66, v16
    v_cvt_pk_bf16_f32 v16, v16, v16
    v_mov_b32 v32, v33
    v_mov_b32 v33, v34
    v_mov_b32 v34, v35
    v_mov_b32 v35, v36
    v_mov_b32 v36, v37
    v_mov_b32 v37, v38
    v_mov_b32 v38, v39
    v_and_b32 v39, 0xffff0000, v16
    s_waitcnt vmcnt(28)
    v_dot2_f32_bf16 v16, v128, v52, 0
    v_dot2_f32_bf16 v17, v132, v52, 0
    v_dot2_f32_bf16 v18, v136, v52, 0
    v_dot2_f32_bf16 v19, v140, v52, 0
    v_dot2_f32_bf16 v16, v129, v53, v16
    v_dot2_f32_bf16 v17, v133, v53, v17
    v_dot2_f32_bf16 v18, v137, v53, v18
    v_dot2_f32_bf16 v19, v141, v53, v19
    v_dot2_f32_bf16 v16, v130, v54, v16
    v_dot2_f32_bf16 v17, v134, v54, v17
    v_dot2_f32_bf16 v18, v138, v54, v18
    v_dot2_f32_bf16 v19, v142, v54, v19
    v_dot2_f32_bf16 v16, v131, v55, v16
    v_dot2_f32_bf16 v17, v135, v55, v17
    v_dot2_f32_bf16 v18, v139, v55, v18
    v_dot2_f32_bf16 v19, v143, v55, v19
    s_add_u32 s54, s52, s53
    s_waitcnt vmcnt(5)
    buffer_load_dwordx4 v[128:131], v8, s[36:39], s54 offen nt
    s_waitcnt vmcnt(5)
    buffer_load_dwordx4 v[132:135], v9, s[36:39], s54 offen nt
    s_waitcnt vmcnt(5)
    buffer_load_dwordx4 v[136:139], v10, s[36:39], s54 offen nt
    s_waitcnt vmcnt(5)
    buffer_load_dwordx4 v[140:143], v7, s[36:39], s54 offen nt
    s_or_b32 s53, s53, 0xffe977ff
    s_add_u32 s53, s53, 1
    s_and_b32 s53, s53, 0x168800
    s_waitcnt vmcnt(28)
    v_dot2_f32_bf16 v20, v144, v52, 0
    v_dot2_f32_bf16 v21, v148, v52, 0
    v_dot2_f32_bf16 v22, v152, v52, 0
    v_dot2_f32_bf16 v23, v156, v52, 0
    v_dot2_f32_bf16 v20, v145, v53, v20
    v_dot2_f32_bf16 v21, v149, v53, v21
    v_dot2_f32_bf16 v22, v153, v53, v22
    v_dot2_f32_bf16 v23, v157, v53, v23
    v_dot2_f32_bf16 v20, v146, v54, v20
    v_dot2_f32_bf16 v21, v150, v54, v21
    v_dot2_f32_bf16 v22, v154, v54, v22
    v_dot2_f32_bf16 v23, v158, v54, v23
    v_dot2_f32_bf16 v20, v147, v55, v20
    v_dot2_f32_bf16 v21, v151, v55, v21
    v_dot2_f32_bf16 v22, v155, v55, v22
    v_dot2_f32_bf16 v23, v159, v55, v23
    s_add_u32 s54, s52, s53
    s_waitcnt vmcnt(5)
    buffer_load_dwordx4 v[144:147], v8, s[36:39], s54 offen nt
    s_waitcnt vmcnt(5)
    buffer_load_dwordx4 v[148:151], v9, s[36:39], s54 offen nt
    s_waitcnt vmcnt(5)
    buffer_load_dwordx4 v[152:155], v10, s[36:39], s54 offen nt
    s_waitcnt vmcnt(5)
    buffer_load_dwordx4 v[156:159], v7, s[36:39], s54 offen nt
    s_or_b32 s53, s53, 0xffe977ff
    s_add_u32 s53, s53, 1
    s_and_b32 s53, s53, 0x168800
    s_waitcnt vmcnt(28)
    v_dot2_f32_bf16 v24, v160, v52, 0
    v_dot2_f32_bf16 v25, v164, v52, 0
    v_dot2_f32_bf16 v26, v168, v52, 0
    v_dot2_f32_bf16 v27, v172, v52, 0
    v_dot2_f32_bf16 v24, v161, v53, v24
    v_dot2_f32_bf16 v25, v165, v53, v25
    v_dot2_f32_bf16 v26, v169, v53, v26
    v_dot2_f32_bf16 v27, v173, v53, v27
    v_dot2_f32_bf16 v24, v162, v54, v24
    v_dot2_f32_bf16 v25, v166, v54, v25
    v_dot2_f32_bf16 v26, v170, v54, v26
    v_dot2_f32_bf16 v27, v174, v54, v27
    v_dot2_f32_bf16 v24, v163, v55, v24
    v_dot2_f32_bf16 v25, v167, v55, v25
    v_dot2_f32_bf16 v26, v171, v55, v26
    v_dot2_f32_bf16 v27, v175, v55, v27
    s_add_u32 s54, s52, s53
    s_waitcnt vmcnt(5)
    buffer_load_dwordx4 v[160:163], v8, s[36:39], s54 offen nt
    s_waitcnt vmcnt(5)
    buffer_load_dwordx4 v[164:167], v9, s[36:39], s54 offen nt
    s_waitcnt vmcnt(5)
    buffer_load_dwordx4 v[168:171], v10, s[36:39], s54 offen nt
    s_waitcnt vmcnt(5)
    buffer_load_dwordx4 v[172:175], v7, s[36:39], s54 offen nt
    s_or_b32 s53, s53, 0xffe977ff
    s_add_u32 s53, s53, 1
    s_and_b32 s53, s53, 0x168800
    s_waitcnt vmcnt(28)
    v_dot2_f32_bf16 v28, v176, v52, 0
    v_dot2_f32_bf16 v29, v180, v52, 0
    v_dot2_f32_bf16 v30, v184, v52, 0
    v_dot2_f32_bf16 v31, v188, v52, 0
    v_dot2_f32_bf16 v28, v177, v53, v28
    v_dot2_f32_bf16 v29, v181, v53, v29
    v_dot2_f32_bf16 v30, v185, v53, v30
    v_dot2_f32_bf16 v31, v189, v53, v31
    v_dot2_f32_bf16 v28, v178, v54, v28
    v_dot2_f32_bf16 v29, v182, v54, v29
    v_dot2_f32_bf16 v30, v186, v54, v30
    v_dot2_f32_bf16 v31, v190, v54, v31
    v_dot2_f32_bf16 v28, v179, v55, v28
    v_dot2_f32_bf16 v29, v183, v55, v29
    v_dot2_f32_bf16 v30, v187, v55, v30
    v_dot2_f32_bf16 v31, v191, v55, v31
    s_add_u32 s54, s52, s53
    s_waitcnt vmcnt(5)
    buffer_load_dwordx4 v[176:179], v8, s[36:39], s54 offen nt
    s_waitcnt vmcnt(5)
    buffer_load_dwordx4 v[180:183], v9, s[36:39], s54 offen nt
    s_waitcnt vmcnt(5)
    buffer_load_dwordx4 v[184:187], v10, s[36:39], s54 offen nt
    s_waitcnt vmcnt(5)
    buffer_load_dwordx4 v[188:191], v7, s[36:39], s54 offen nt
    s_or_b32 s53, s53, 0xffe977ff
    s_add_u32 s53, s53, 1
    s_and_b32 s53, s53, 0x168800
    v_add_f32_dpp v16, v16, v16 row_ror:8 row_mask:0xf bank_mask:0x3
    v_add_f32_dpp v17, v17, v17 row_ror:8 row_mask:0xf bank_mask:0x3
    v_add_f32_dpp v18, v18, v18 row_ror:8 row_mask:0xf bank_mask:0x3
    v_add_f32_dpp v19, v19, v19 row_ror:8 row_mask:0xf bank_mask:0x3
    v_add_f32_dpp v20, v20, v20 row_ror:8 row_mask:0xf bank_mask:0x3
    v_add_f32_dpp v21, v21, v21 row_ror:8 row_mask:0xf bank_mask:0x3
    v_add_f32_dpp v22, v22, v22 row_ror:8 row_mask:0xf bank_mask:0x3
    v_add_f32_dpp v23, v23, v23 row_ror:8 row_mask:0xf bank_mask:0x3
    v_add_f32_dpp v16, v24, v24 row_ror:8 row_mask:0xf bank_mask:0xc
    v_add_f32_dpp v17, v25, v25 row_ror:8 row_mask:0xf bank_mask:0xc
    v_add_f32_dpp v18, v26, v26 row_ror:8 row_mask:0xf bank_mask:0xc
    v_add_f32_dpp v19, v27, v27 row_ror:8 row_mask:0xf bank_mask:0xc
    v_add_f32_dpp v20, v28, v28 row_ror:8 row_mask:0xf bank_mask:0xc
    v_add_f32_dpp v21, v29, v29 row_ror:8 row_mask:0xf bank_mask:0xc
    v_add_f32_dpp v22, v30, v30 row_ror:8 row_mask:0xf bank_mask:0xc
    v_add_f32_dpp v23, v31, v31 row_ror:8 row_mask:0xf bank_mask:0xc
    v_add_f32_dpp v16, v16, v16 row_half_mirror row_mask:0xf bank_mask:0x5
    v_add_f32_dpp v17, v17, v17 row_half_mirror row_mask:0xf bank_mask:0x5
    v_add_f32_dpp v18, v18, v18 row_half_mirror row_mask:0xf bank_mask:0x5
    v_add_f32_dpp v19, v19, v19 row_half_mirror row_mask:0xf bank_mask:0x5
    s_nop 0
    v_add_f32_dpp v16, v20, v20 row_half_mirror row_mask:0xf bank_mask:0xa
    v_add_f32_dpp v17, v21, v21 row_half_mirror row_mask:0xf bank_mask:0xa
    v_add_f32_dpp v18, v22, v22 row_half_mirror row_mask:0xf bank_mask:0xa
    v_add_f32_dpp v19, v23, v23 row_half_mirror row_mask:0xf bank_mask:0xa
    s_nop 1
    v_add_f32_dpp v16, v16, v16 quad_perm:[2,3,0,1] row_mask:0xf bank_mask:0xf
    v_add_f32_dpp v17, v17, v17 quad_perm:[2,3,0,1] row_mask:0xf bank_mask:0xf
    v_add_f32_dpp v18, v18, v18 quad_perm:[2,3,0,1] row_mask:0xf bank_mask:0xf
    v_add_f32_dpp v19, v19, v19 quad_perm:[2,3,0,1] row_mask:0xf bank_mask:0xf
    v_cndmask_b32_e64 v16, v16, v18, s[62:63]
    v_cndmask_b32_e64 v17, v17, v19, s[62:63]
    s_nop 1
    v_add_f32_dpp v16, v16, v16 quad_perm:[1,0,3,2] row_mask:0xf bank_mask:0xf
    v_add_f32_dpp v17, v17, v17 quad_perm:[1,0,3,2] row_mask:0xf bank_mask:0xf
    v_cndmask_b32_e64 v16, v16, v17, s[64:65]
    v_cvt_pk_bf16_f32 v16, v16, v16
    v_and_b32 v16, 0xffff0000, v16
    v_mul_f32 v16, s66, v16
    v_cvt_pk_bf16_f32 v16, v16, v16
    v_mov_b32 v32, v33
    v_mov_b32 v33, v34
    v_mov_b32 v34, v35
    v_mov_b32 v35, v36
    v_mov_b32 v36, v37
    v_mov_b32 v37, v38
    v_mov_b32 v38, v39
    v_and_b32 v39, 0xffff0000, v16
    s_add_u32 s55, s55, 1
    s_cmp_lt_u32 s55, 4
    s_cbranch_scc1 L_kloop
    v_max3_f32 v60, v32, v33, v34
    v_max3_f32 v61, v35, v36, v37
    v_max3_f32 v60, v60, v38, v39
    v_max_f32 v60, v60, v61
    s_nop 1
    v_max_f32_dpp v60, v60, v60 row_ror:8 row_mask:0xf bank_mask:0xf
    s_nop 1
    v_max_f32_dpp v60, v60, v60 row_ror:4 row_mask:0xf bank_mask:0xf
    s_nop 1
    v_max_f32_dpp v60, v60, v60 row_ror:2 row_mask:0xf bank_mask:0xf
    s_nop 1
    v_max_f32_dpp v60, v60, v60 row_ror:1 row_mask:0xf bank_mask:0xf
    s_nop 1
    v_max_f32_dpp v60, v60, v60 row_bcast:15 row_mask:0xa bank_mask:0xf
    s_nop 1
    v_max_f32_dpp v60, v60, v60 row_bcast:31 row_mask:0xc bank_mask:0xf
    s_nop 1
    v_readlane_b32 s56, v60, 63
    s_nop 1
    v_subrev_f32 v32, s56, v32
    v_subrev_f32 v33, s56, v33
    v_subrev_f32 v34, s56, v34
    v_subrev_f32 v35, s56, v35
    v_subrev_f32 v36, s56, v36
    v_subrev_f32 v37, s56, v37
    v_subrev_f32 v38, s56, v38
    v_subrev_f32 v39, s56, v39
    v_mul_f32 v32, s67, v32
    v_mul_f32 v33, s67, v33
    v_mul_f32 v34, s67, v34
    v_mul_f32 v35, s67, v35
    v_mul_f32 v36, s67, v36
    v_mul_f32 v37, s67, v37
    v_mul_f32 v38, s67, v38
    v_mul_f32 v39, s67, v39
    v_exp_f32 v32, v32
    v_exp_f32 v33, v33
    v_exp_f32 v34, v34
    v_exp_f32 v35, v35
    v_exp_f32 v36, v36
    v_exp_f32 v37, v37
    v_exp_f32 v38, v38
    v_exp_f32 v39, v39
    s_nop 0
    v_add_f32 v60, v32, v33
    v_add_f32 v61, v34, v35
    v_add_f32 v62, v36, v37
    v_add_f32 v63, v38, v39
    v_add_f32 v60, v60, v61
    v_add_f32 v62, v62, v63
    v_add_f32 v61, v60, v62
    s_nop 1
    v_add_f32_dpp v61, v61, v61 row_ror:8 row_mask:0xf bank_mask:0xf
    s_nop 1
    v_add_f32_dpp v61, v61, v61 row_ror:4 row_mask:0xf bank_mask:0xf
    s_nop 1
    v_add_f32_dpp v61, v61, v61 row_ror:2 row_mask:0xf bank_mask:0xf
    s_nop 1
    v_add_f32_dpp v61, v61, v61 row_ror:1 row_mask:0xf bank_mask:0xf
    s_nop 1
    v_add_f32_dpp v61, v61, v61 row_bcast:15 row_mask:0xa bank_mask:0xf
    s_nop 1
    v_add_f32_dpp v61, v61, v61 row_bcast:31 row_mask:0xc bank_mask:0xf
    v_mov_b32 v60, s56
    v_cvt_pk_bf16_f32 v32, v32, v32
    v_cvt_pk_bf16_f32 v33, v33, v33
    v_cvt_pk_bf16_f32 v34, v34, v34
    v_cvt_pk_bf16_f32 v35, v35, v35
    v_cvt_pk_bf16_f32 v36, v36, v36
    v_cvt_pk_bf16_f32 v37, v37, v37
    v_cvt_pk_bf16_f32 v38, v38, v38
    v_cvt_pk_bf16_f32 v39, v39, v39
    s_lshl_b32 s57, s33, 3
    s_add_u32 s57, s57, 2048
    v_mov_b32 v13, s57
    v_mov_b32 v14, 2080
    v_mov_b32 v15, 1
    s_mov_b32 exec_lo, 0
    s_mov_b32 exec_hi, 0x80000000
    ds_write_b64 v13, v[60:61]
    ds_add_u32 v14, v15
    s_mov_b64 exec, -1
    v_mov_b32 v48, 0
    v_mov_b32 v49, 0
    v_mov_b32 v50, 0
    v_mov_b32 v51, 0
    s_mov_b32 s55, 0
L_vloop:
    v_and_b32_dpp v40, v32, v56 row_newbcast:0 row_mask:0xf bank_mask:0xf
    v_and_b32_dpp v41, v32, v57 row_newbcast:0 row_mask:0xf bank_mask:0xf
    v_and_b32_dpp v42, v32, v58 row_newbcast:0 row_mask:0xf bank_mask:0xf
    v_and_b32_dpp v43, v32, v59 row_newbcast:0 row_mask:0xf bank_mask:0xf
    s_waitcnt vmcnt(28)
    ds_read_b32 v11, v14 offset:8
    v_and_b32_dpp v44, v32, v56 row_newbcast:1 row_mask:0xf bank_mask:0xf
    v_and_b32_dpp v45, v32, v57 row_newbcast:1 row_mask:0xf bank_mask:0xf
    v_and_b32_dpp v46, v32, v58 row_newbcast:1 row_mask:0xf bank_mask:0xf
    v_and_b32_dpp v47, v32, v59 row_newbcast:1 row_mask:0xf bank_mask:0xf
    v_mfma_f32_16x16x32_bf16 v[48:51], v[40:43], v[64:67], v[48:51]
    v_and_b32_dpp v40, v32, v56 row_newbcast:2 row_mask:0xf bank_mask:0xf
    v_and_b32_dpp v41, v32, v57 row_newbcast:2 row_mask:0xf bank_mask:0xf
    v_and_b32_dpp v42, v32, v58 row_newbcast:2 row_mask:0xf bank_mask:0xf
    v_and_b32_dpp v43, v32, v59 row_newbcast:2 row_mask:0xf bank_mask:0xf
    v_mfma_f32_16x16x32_bf16 v[48:51], v[44:47], v[68:71], v[48:51]
    v_and_b32_dpp v44, v32, v56 row_newbcast:3 row_mask:0xf bank_mask:0xf
    v_and_b32_dpp v45, v32, v57 row_newbcast:3 row_mask:0xf bank_mask:0xf
    v_and_b32_dpp v46, v32, v58 row_newbcast:3 row_mask:0xf bank_mask:0xf
    v_and_b32_dpp v47, v32, v59 row_newbcast:3 row_mask:0xf bank_mask:0xf
    v_mfma_f32_16x16x32_bf16 v[48:51], v[40:43], v[72:75], v[48:51]
    v_and_b32_dpp v40, v32, v56 row_newbcast:4 row_mask:0xf bank_mask:0xf
    v_and_b32_dpp v41, v32, v57 row_newbcast:4 row_mask:0xf bank_mask:0xf
    v_and_b32_dpp v42, v32, v58 row_newbcast:4 row_mask:0xf bank_mask:0xf
    v_and_b32_dpp v43, v32, v59 row_newbcast:4 row_mask:0xf bank_mask:0xf
    v_mfma_f32_16x16x32_bf16 v[48:51], v[44:47], v[76:79], v[48:51]
    s_waitcnt lgkmcnt(0)
    v_readfirstlane_b32 s58, v11
    s_add_u32 s54, s52, s53
    s_nop 1
    s_waitcnt vmcnt(8)
    s_bitcmp1_b32 s58, 0
    s_cbranch_scc1 L_bo1
    s_waitcnt vmcnt(5)
L_bo1:
    buffer_load_dwordx4 v[64:67], v8, s[36:39], s54 offen nt
    s_waitcnt vmcnt(8)
    s_bitcmp1_b32 s58, 1
    s_cbranch_scc1 L_bo2
    s_waitcnt vmcnt(5)
L_bo2:
    buffer_load_dwordx4 v[68:71], v9, s[36:39], s54 offen nt
    s_waitcnt vmcnt(8)
    s_bitcmp1_b32 s58, 2
    s_cbranch_scc1 L_bo3
    s_waitcnt vmcnt(5)
L_bo3:
    buffer_load_dwordx4 v[72:75], v10, s[36:39], s54 offen nt
    s_waitcnt vmcnt(8)
    s_bitcmp1_b32 s58, 3
    s_cbranch_scc1 L_bo4
    s_waitcnt vmcnt(5)
L_bo4:
    buffer_load_dwordx4 v[76:79], v7, s[36:39], s54 offen nt
    s_or_b32 s53, s53, 0xffe977ff
    s_add_u32 s53, s53, 1
    s_and_b32 s53, s53, 0x168800
    s_waitcnt vmcnt(28)
    ds_read_b32 v11, v14 offset:8
    v_and_b32_dpp v44, v32, v56 row_newbcast:5 row_mask:0xf bank_mask:0xf
    v_and_b32_dpp v45, v32, v57 row_newbcast:5 row_mask:0xf bank_mask:0xf
    v_and_b32_dpp v46, v32, v58 row_newbcast:5 row_mask:0xf bank_mask:0xf
    v_and_b32_dpp v47, v32, v59 row_newbcast:5 row_mask:0xf bank_mask:0xf
    v_mfma_f32_16x16x32_bf16 v[48:51], v[40:43], v[80:83], v[48:51]
    v_and_b32_dpp v40, v32, v56 row_newbcast:6 row_mask:0xf bank_mask:0xf
    v_and_b32_dpp v41, v32, v57 row_newbcast:6 row_mask:0xf bank_mask:0xf
    v_and_b32_dpp v42, v32, v58 row_newbcast:6 row_mask:0xf bank_mask:0xf
    v_and_b32_dpp v43, v32, v59 row_newbcast:6 row_mask:0xf bank_mask:0xf
    v_mfma_f32_16x16x32_bf16 v[48:51], v[44:47], v[84:87], v[48:51]
    v_and_b32_dpp v44, v32, v56 row_newbcast:7 row_mask:0xf bank_mask:0xf
    v_and_b32_dpp v45, v32, v57 row_newbcast:7 row_mask:0xf bank_mask:0xf
    v_and_b32_dpp v46, v32, v58 row_newbcast:7 row_mask:0xf bank_mask:0xf
    v_and_b32_dpp v47, v32, v59 row_newbcast:7 row_mask:0xf bank_mask:0xf
    v_mfma_f32_16x16x32_bf16 v[48:51], v[40:43], v[88:91], v[48:51]
    v_and_b32_dpp v40, v32, v56 row_newbcast:8 row_mask:0xf bank_mask:0xf
    v_and_b32_dpp v41, v32, v57 row_newbcast:8 row_mask:0xf bank_mask:0xf
    v_and_b32_dpp v42, v32, v58 row_newbcast:8 row_mask:0xf bank_mask:0xf
    v_and_b32_dpp v43, v32, v59 row_newbcast:8 row_mask:0xf bank_mask:0xf
    v_mfma_f32_16x16x32_bf16 v[48:51], v[44:47], v[92:95], v[48:51]
    s_waitcnt lgkmcnt(0)
    v_readfirstlane_b32 s58, v11
    s_add_u32 s54, s52, s53
    s_nop 1
    s_waitcnt vmcnt(8)
    s_bitcmp1_b32 s58, 4
    s_cbranch_scc1 L_bo5
    s_waitcnt vmcnt(5)
L_bo5:
    buffer_load_dwordx4 v[80:83], v8, s[36:39], s54 offen nt
    s_waitcnt vmcnt(8)
    s_bitcmp1_b32 s58, 5
    s_cbranch_scc1 L_bo6
    s_waitcnt vmcnt(5)
L_bo6:
    buffer_load_dwordx4 v[84:87], v9, s[36:39], s54 offen nt
    s_waitcnt vmcnt(8)
    s_bitcmp1_b32 s58, 6
    s_cbranch_scc1 L_bo7
    s_waitcnt vmcnt(5)
L_bo7:
    buffer_load_dwordx4 v[88:91], v10, s[36:39], s54 offen nt
    s_waitcnt vmcnt(8)
    s_bitcmp1_b32 s58, 7
    s_cbranch_scc1 L_bo8
    s_waitcnt vmcnt(5)
L_bo8:
    buffer_load_dwordx4 v[92:95], v7, s[36:39], s54 offen nt
    s_or_b32 s53, s53, 0xffe977ff
    s_add_u32 s53, s53, 1
    s_and_b32 s53, s53, 0x168800
    s_waitcnt vmcnt(28)
    ds_read_b32 v11, v14 offset:8
    v_and_b32_dpp v44, v32, v56 row_newbcast:9 row_mask:0xf bank_mask:0xf
    v_and_b32_dpp v45, v32, v57 row_newbcast:9 row_mask:0xf bank_mask:0xf
    v_and_b32_dpp v46, v32, v58 row_newbcast:9 row_mask:0xf bank_mask:0xf
    v_and_b32_dpp v47, v32, v59 row_newbcast:9 row_mask:0xf bank_mask:0xf
    v_mfma_f32_16x16x32_bf16 v[48:51], v[40:43], v[96:99], v[48:51]
    v_and_b32_dpp v40, v32, v56 row_newbcast:10 row_mask:0xf bank_mask:0xf
    v_and_b32_dpp v41, v32, v57 row_newbcast:10 row_mask:0xf bank_mask:0xf
    v_and_b32_dpp v42, v32, v58 row_newbcast:10 row_mask:0xf bank_mask:0xf
    v_and_b32_dpp v43, v32, v59 row_newbcast:10 row_mask:0xf bank_mask:0xf
    v_mfma_f32_16x16x32_bf16 v[48:51], v[44:47], v[100:103], v[48:51]
    v_and_b32_dpp v44, v32, v56 row_newbcast:11 row_mask:0xf bank_mask:0xf
    v_and_b32_dpp v45, v32, v57 row_newbcast:11 row_mask:0xf bank_mask:0xf
    v_and_b32_dpp v46, v32, v58 row_newbcast:11 row_mask:0xf bank_mask:0xf
    v_and_b32_dpp v47, v32, v59 row_newbcast:11 row_mask:0xf bank_mask:0xf
    v_mfma_f32_16x16x32_bf16 v[48:51], v[40:43], v[104:107], v[48:51]
    v_and_b32_dpp v40, v32, v56 row_newbcast:12 row_mask:0xf bank_mask:0xf
    v_and_b32_dpp v41, v32, v57 row_newbcast:12 row_mask:0xf bank_mask:0xf
    v_and_b32_dpp v42, v32, v58 row_newbcast:12 row_mask:0xf bank_mask:0xf
    v_and_b32_dpp v43, v32, v59 row_newbcast:12 row_mask:0xf bank_mask:0xf
    v_mfma_f32_16x16x32_bf16 v[48:51], v[44:47], v[108:111], v[48:51]
    s_waitcnt lgkmcnt(0)
    v_readfirstlane_b32 s58, v11
    s_add_u32 s54, s52, s53
    s_nop 1
    s_waitcnt vmcnt(8)
    s_bitcmp1_b32 s58, 8
    s_cbranch_scc1 L_bo9
    s_waitcnt vmcnt(5)
L_bo9:
    buffer_load_dwordx4 v[96:99], v8, s[36:39], s54 offen nt
    s_waitcnt vmcnt(8)
    s_bitcmp1_b32 s58, 9
    s_cbranch_scc1 L_bo10
    s_waitcnt vmcnt(5)
L_bo10:
    buffer_load_dwordx4 v[100:103], v9, s[36:39], s54 offen nt
    s_waitcnt vmcnt(8)
    s_bitcmp1_b32 s58, 10
    s_cbranch_scc1 L_bo11
    s_waitcnt vmcnt(5)
L_bo11:
    buffer_load_dwordx4 v[104:107], v10, s[36:39], s54 offen nt
    s_waitcnt vmcnt(8)
    s_bitcmp1_b32 s58, 11
    s_cbranch_scc1 L_bo12
    s_waitcnt vmcnt(5)
L_bo12:
    buffer_load_dwordx4 v[108:111], v7, s[36:39], s54 offen nt
    s_or_b32 s53, s53, 0xffe977ff
    s_add_u32 s53, s53, 1
    s_and_b32 s53, s53, 0x168800
    s_waitcnt vmcnt(28)
    ds_read_b32 v11, v14 offset:8
    v_and_b32_dpp v44, v32, v56 row_newbcast:13 row_mask:0xf bank_mask:0xf
    v_and_b32_dpp v45, v32, v57 row_newbcast:13 row_mask:0xf bank_mask:0xf
    v_and_b32_dpp v46, v32, v58 row_newbcast:13 row_mask:0xf bank_mask:0xf
    v_and_b32_dpp v47, v32, v59 row_newbcast:13 row_mask:0xf bank_mask:0xf
    v_mfma_f32_16x16x32_bf16 v[48:51], v[40:43], v[112:115], v[48:51]
    v_and_b32_dpp v40, v32, v56 row_newbcast:14 row_mask:0xf bank_mask:0xf
    v_and_b32_dpp v41, v32, v57 row_newbcast:14 row_mask:0xf bank_mask:0xf
    v_and_b32_dpp v42, v32, v58 row_newbcast:14 row_mask:0xf bank_mask:0xf
    v_and_b32_dpp v43, v32, v59 row_newbcast:14 row_mask:0xf bank_mask:0xf
    v_mfma_f32_16x16x32_bf16 v[48:51], v[44:47], v[116:119], v[48:51]
    v_and_b32_dpp v44, v32, v56 row_newbcast:15 row_mask:0xf bank_mask:0xf
    v_and_b32_dpp v45, v32, v57 row_newbcast:15 row_mask:0xf bank_mask:0xf
    v_and_b32_dpp v46, v32, v58 row_newbcast:15 row_mask:0xf bank_mask:0xf
    v_and_b32_dpp v47, v32, v59 row_newbcast:15 row_mask:0xf bank_mask:0xf
    v_mfma_f32_16x16x32_bf16 v[48:51], v[40:43], v[120:123], v[48:51]
    v_and_b32_dpp v40, v33, v56 row_newbcast:0 row_mask:0xf bank_mask:0xf
    v_and_b32_dpp v41, v33, v57 row_newbcast:0 row_mask:0xf bank_mask:0xf
    v_and_b32_dpp v42, v33, v58 row_newbcast:0 row_mask:0xf bank_mask:0xf
    v_and_b32_dpp v43, v33, v59 row_newbcast:0 row_mask:0xf bank_mask:0xf
    v_mfma_f32_16x16x32_bf16 v[48:51], v[44:47], v[124:127], v[48:51]
    s_waitcnt lgkmcnt(0)
    v_readfirstlane_b32 s58, v11
    s_add_u32 s54, s52, s53
    s_nop 1
    s_waitcnt vmcnt(8)
    s_bitcmp1_b32 s58, 12
    s_cbranch_scc1 L_bo13
    s_waitcnt vmcnt(5)
L_bo13:
    buffer_load_dwordx4 v[112:115], v8, s[36:39], s54 offen nt
    s_waitcnt vmcnt(8)
    s_bitcmp1_b32 s58, 13
    s_cbranch_scc1 L_bo14
    s_waitcnt vmcnt(5)
L_bo14:
    buffer_load_dwordx4 v[116:119], v9, s[36:39], s54 offen nt
    s_waitcnt vmcnt(8)
    s_bitcmp1_b32 s58, 14
    s_cbranch_scc1 L_bo15
    s_waitcnt vmcnt(5)
L_bo15:
    buffer_load_dwordx4 v[120:123], v10, s[36:39], s54 offen nt
    s_waitcnt vmcnt(8)
    s_bitcmp1_b32 s58, 15
    s_cbranch_scc1 L_bo16
    s_waitcnt vmcnt(5)
L_bo16:
    buffer_load_dwordx4 v[124:127], v7, s[36:39], s54 offen nt
    s_or_b32 s53, s53, 0xffe977ff
    s_add_u32 s53, s53, 1
    s_and_b32 s53, s53, 0x168800
    s_waitcnt vmcnt(28)
    s_cmp_lg_u32 s55, 2
    s_cbranch_scc1 L_v_notrig
    v_mov_b32 v15, 0x100
    s_mov_b64 exec, 1
    ds_add_u32 v14, v15
    s_mov_b64 exec, -1
L_v_notrig:
    ds_read_b32 v11, v14 offset:8
    v_and_b32_dpp v44, v33, v56 row_newbcast:1 row_mask:0xf bank_mask:0xf
    v_and_b32_dpp v45, v33, v57 row_newbcast:1 row_mask:0xf bank_mask:0xf
    v_and_b32_dpp v46, v33, v58 row_newbcast:1 row_mask:0xf bank_mask:0xf
    v_and_b32_dpp v47, v33, v59 row_newbcast:1 row_mask:0xf bank_mask:0xf
    v_mfma_f32_16x16x32_bf16 v[48:51], v[40:43], v[128:131], v[48:51]
    v_and_b32_dpp v40, v33, v56 row_newbcast:2 row_mask:0xf bank_mask:0xf
    v_and_b32_dpp v41, v33, v57 row_newbcast:2 row_mask:0xf bank_mask:0xf
    v_and_b32_dpp v42, v33, v58 row_newbcast:2 row_mask:0xf bank_mask:0xf
    v_and_b32_dpp v43, v33, v59 row_newbcast:2 row_mask:0xf bank_mask:0xf
    v_mfma_f32_16x16x32_bf16 v[48:51], v[44:47], v[132:135], v[48:51]
    v_and_b32_dpp v44, v33, v56 row_newbcast:3 row_mask:0xf bank_mask:0xf
    v_and_b32_dpp v45, v33, v57 row_newbcast:3 row_mask:0xf bank_mask:0xf
    v_and_b32_dpp v46, v33, v58 row_newbcast:3 row_mask:0xf bank_mask:0xf
    v_and_b32_dpp v47, v33, v59 row_newbcast:3 row_mask:0xf bank_mask:0xf
    v_mfma_f32_16x16x32_bf16 v[48:51], v[40:43], v[136:139], v[48:51]
    v_and_b32_dpp v40, v33, v56 row_newbcast:4 row_mask:0xf bank_mask:0xf
    v_and_b32_dpp v41, v33, v57 row_newbcast:4 row_mask:0xf bank_mask:0xf
    v_and_b32_dpp v42, v33, v58 row_newbcast:4 row_mask:0xf bank_mask:0xf
    v_and_b32_dpp v43, v33, v59 row_newbcast:4 row_mask:0xf bank_mask:0xf
    v_mfma_f32_16x16x32_bf16 v[48:51], v[44:47], v[140:143], v[48:51]
    s_waitcnt lgkmcnt(0)
    v_readfirstlane_b32 s58, v11
    s_add_u32 s54, s52, s53
    s_nop 1
    s_waitcnt vmcnt(8)
    s_bitcmp1_b32 s58, 16
    s_cbranch_scc1 L_bo17
    s_waitcnt vmcnt(5)
L_bo17:
    buffer_load_dwordx4 v[128:131], v8, s[36:39], s54 offen nt
    s_waitcnt vmcnt(8)
    s_bitcmp1_b32 s58, 17
    s_cbranch_scc1 L_bo18
    s_waitcnt vmcnt(5)
L_bo18:
    buffer_load_dwordx4 v[132:135], v9, s[36:39], s54 offen nt
    s_waitcnt vmcnt(8)
    s_bitcmp1_b32 s58, 18
    s_cbranch_scc1 L_bo19
    s_waitcnt vmcnt(5)
L_bo19:
    buffer_load_dwordx4 v[136:139], v10, s[36:39], s54 offen nt
    s_waitcnt vmcnt(8)
    s_bitcmp1_b32 s58, 19
    s_cbranch_scc1 L_bo20
    s_waitcnt vmcnt(5)
L_bo20:
    buffer_load_dwordx4 v[140:143], v7, s[36:39], s54 offen nt
    s_or_b32 s53, s53, 0xffe977ff
    s_add_u32 s53, s53, 1
    s_and_b32 s53, s53, 0x168800
    s_waitcnt vmcnt(28)
    ds_read_b32 v11, v14 offset:8
    v_and_b32_dpp v44, v33, v56 row_newbcast:5 row_mask:0xf bank_mask:0xf
    v_and_b32_dpp v45, v33, v57 row_newbcast:5 row_mask:0xf bank_mask:0xf
    v_and_b32_dpp v46, v33, v58 row_newbcast:5 row_mask:0xf bank_mask:0xf
    v_and_b32_dpp v47, v33, v59 row_newbcast:5 row_mask:0xf bank_mask:0xf
    v_mfma_f32_16x16x32_bf16 v[48:51], v[40:43], v[144:147], v[48:51]
    v_and_b32_dpp v40, v33, v56 row_newbcast:6 row_mask:0xf bank_mask:0xf
    v_and_b32_dpp v41, v33, v57 row_newbcast:6 row_mask:0xf bank_mask:0xf
    v_and_b32_dpp v42, v33, v58 row_newbcast:6 row_mask:0xf bank_mask:0xf
    v_and_b32_dpp v43, v33, v59 row_newbcast:6 row_mask:0xf bank_mask:0xf
    v_mfma_f32_16x16x32_bf16 v[48:51], v[44:47], v[148:151], v[48:51]
    v_and_b32_dpp v44, v33, v56 row_newbcast:7 row_mask:0xf bank_mask:0xf
    v_and_b32_dpp v45, v33, v57 row_newbcast:7 row_mask:0xf bank_mask:0xf
    v_and_b32_dpp v46, v33, v58 row_newbcast:7 row_mask:0xf bank_mask:0xf
    v_and_b32_dpp v47, v33, v59 row_newbcast:7 row_mask:0xf bank_mask:0xf
    v_mfma_f32_16x16x32_bf16 v[48:51], v[40:43], v[152:155], v[48:51]
    v_and_b32_dpp v40, v33, v56 row_newbcast:8 row_mask:0xf bank_mask:0xf
    v_and_b32_dpp v41, v33, v57 row_newbcast:8 row_mask:0xf bank_mask:0xf
    v_and_b32_dpp v42, v33, v58 row_newbcast:8 row_mask:0xf bank_mask:0xf
    v_and_b32_dpp v43, v33, v59 row_newbcast:8 row_mask:0xf bank_mask:0xf
    v_mfma_f32_16x16x32_bf16 v[48:51], v[44:47], v[156:159], v[48:51]
    s_waitcnt lgkmcnt(0)
    v_readfirstlane_b32 s58, v11
    s_add_u32 s54, s52, s53
    s_nop 1
    s_waitcnt vmcnt(8)
    s_bitcmp1_b32 s58, 20
    s_cbranch_scc1 L_bo21
    s_waitcnt vmcnt(5)
L_bo21:
    buffer_load_dwordx4 v[144:147], v8, s[36:39], s54 offen nt
    s_waitcnt vmcnt(8)
    s_bitcmp1_b32 s58, 21
    s_cbranch_scc1 L_bo22
    s_waitcnt vmcnt(5)
L_bo22:
    buffer_load_dwordx4 v[148:151], v9, s[36:39], s54 offen nt
    s_waitcnt vmcnt(8)
    s_bitcmp1_b32 s58, 22
    s_cbranch_scc1 L_bo23
    s_waitcnt vmcnt(5)
L_bo23:
    buffer_load_dwordx4 v[152:155], v10, s[36:39], s54 offen nt
    s_waitcnt vmcnt(8)
    s_bitcmp1_b32 s58, 23
    s_cbranch_scc1 L_bo24
    s_waitcnt vmcnt(5)
L_bo24:
    buffer_load_dwordx4 v[156:159], v7, s[36:39], s54 offen nt
    s_or_b32 s53, s53, 0xffe977ff
    s_add_u32 s53, s53, 1
    s_and_b32 s53, s53, 0x168800
    s_waitcnt vmcnt(28)
    ds_read_b32 v11, v14 offset:8
    v_and_b32_dpp v44, v33, v56 row_newbcast:9 row_mask:0xf bank_mask:0xf
    v_and_b32_dpp v45, v33, v57 row_newbcast:9 row_mask:0xf bank_mask:0xf
    v_and_b32_dpp v46, v33, v58 row_newbcast:9 row_mask:0xf bank_mask:0xf
    v_and_b32_dpp v47, v33, v59 row_newbcast:9 row_mask:0xf bank_mask:0xf
    v_mfma_f32_16x16x32_bf16 v[48:51], v[40:43], v[160:163], v[48:51]
    v_and_b32_dpp v40, v33, v56 row_newbcast:10 row_mask:0xf bank_mask:0xf
    v_and_b32_dpp v41, v33, v57 row_newbcast:10 row_mask:0xf bank_mask:0xf
    v_and_b32_dpp v42, v33, v58 row_newbcast:10 row_mask:0xf bank_mask:0xf
    v_and_b32_dpp v43, v33, v59 row_newbcast:10 row_mask:0xf bank_mask:0xf
    v_mfma_f32_16x16x32_bf16 v[48:51], v[44:47], v[164:167], v[48:51]
    v_and_b32_dpp v44, v33, v56 row_newbcast:11 row_mask:0xf bank_mask:0xf
    v_and_b32_dpp v45, v33, v57 row_newbcast:11 row_mask:0xf bank_mask:0xf
    v_and_b32_dpp v46, v33, v58 row_newbcast:11 row_mask:0xf bank_mask:0xf
    v_and_b32_dpp v47, v33, v59 row_newbcast:11 row_mask:0xf bank_mask:0xf
    v_mfma_f32_16x16x32_bf16 v[48:51], v[40:43], v[168:171], v[48:51]
    v_and_b32_dpp v40, v33, v56 row_newbcast:12 row_mask:0xf bank_mask:0xf
    v_and_b32_dpp v41, v33, v57 row_newbcast:12 row_mask:0xf bank_mask:0xf
    v_and_b32_dpp v42, v33, v58 row_newbcast:12 row_mask:0xf bank_mask:0xf
    v_and_b32_dpp v43, v33, v59 row_newbcast:12 row_mask:0xf bank_mask:0xf
    v_mfma_f32_16x16x32_bf16 v[48:51], v[44:47], v[172:175], v[48:51]
    s_waitcnt lgkmcnt(0)
    v_readfirstlane_b32 s58, v11
    s_add_u32 s54, s52, s53
    s_nop 1
    s_waitcnt vmcnt(8)
    s_bitcmp1_b32 s58, 24
    s_cbranch_scc1 L_bo25
    s_waitcnt vmcnt(5)
L_bo25:
    buffer_load_dwordx4 v[160:163], v8, s[36:39], s54 offen nt
    s_waitcnt vmcnt(8)
    s_bitcmp1_b32 s58, 25
    s_cbranch_scc1 L_bo26
    s_waitcnt vmcnt(5)
L_bo26:
    buffer_load_dwordx4 v[164:167], v9, s[36:39], s54 offen nt
    s_waitcnt vmcnt(8)
    s_bitcmp1_b32 s58, 26
    s_cbranch_scc1 L_bo27
    s_waitcnt vmcnt(5)
L_bo27:
    buffer_load_dwordx4 v[168:171], v10, s[36:39], s54 offen nt
    s_waitcnt vmcnt(8)
    s_bitcmp1_b32 s58, 27
    s_cbranch_scc1 L_bo28
    s_waitcnt vmcnt(5)
L_bo28:
    buffer_load_dwordx4 v[172:175], v7, s[36:39], s54 offen nt
    s_or_b32 s53, s53, 0xffe977ff
    s_add_u32 s53, s53, 1
    s_and_b32 s53, s53, 0x168800
    s_waitcnt vmcnt(28)
    ds_read_b32 v11, v14 offset:8
    v_and_b32_dpp v44, v33, v56 row_newbcast:13 row_mask:0xf bank_mask:0xf
    v_and_b32_dpp v45, v33, v57 row_newbcast:13 row_mask:0xf bank_mask:0xf
    v_and_b32_dpp v46, v33, v58 row_newbcast:13 row_mask:0xf bank_mask:0xf
    v_and_b32_dpp v47, v33, v59 row_newbcast:13 row_mask:0xf bank_mask:0xf
    v_mfma_f32_16x16x32_bf16 v[48:51], v[40:43], v[176:179], v[48:51]
    v_and_b32_dpp v40, v33, v56 row_newbcast:14 row_mask:0xf bank_mask:0xf
    v_and_b32_dpp v41, v33, v57 row_newbcast:14 row_mask:0xf bank_mask:0xf
    v_and_b32_dpp v42, v33, v58 row_newbcast:14 row_mask:0xf bank_mask:0xf
    v_and_b32_dpp v43, v33, v59 row_newbcast:14 row_mask:0xf bank_mask:0xf
    v_mfma_f32_16x16x32_bf16 v[48:51], v[44:47], v[180:183], v[48:51]
    v_and_b32_dpp v44, v33, v56 row_newbcast:15 row_mask:0xf bank_mask:0xf
    v_and_b32_dpp v45, v33, v57 row_newbcast:15 row_mask:0xf bank_mask:0xf
    v_and_b32_dpp v46, v33, v58 row_newbcast:15 row_mask:0xf bank_mask:0xf
    v_and_b32_dpp v47, v33, v59 row_newbcast:15 row_mask:0xf bank_mask:0xf
    v_mfma_f32_16x16x32_bf16 v[48:51], v[40:43], v[184:187], v[48:51]
    v_mov_b32 v32, v34
    v_mov_b32 v33, v35
    v_mov_b32 v34, v36
    v_mov_b32 v35, v37
    v_mov_b32 v36, v38
    v_mov_b32 v37, v39
    v_mfma_f32_16x16x32_bf16 v[48:51], v[44:47], v[188:191], v[48:51]
    s_waitcnt lgkmcnt(0)
    v_readfirstlane_b32 s58, v11
    s_add_u32 s54, s52, s53
    s_nop 1
    s_waitcnt vmcnt(8)
    s_bitcmp1_b32 s58, 28
    s_cbranch_scc1 L_bo29
    s_waitcnt vmcnt(5)
L_bo29:
    buffer_load_dwordx4 v[176:179], v8, s[36:39], s54 offen nt
    s_waitcnt vmcnt(8)
    s_bitcmp1_b32 s58, 29
    s_cbranch_scc1 L_bo30
    s_waitcnt vmcnt(5)
L_bo30:
    buffer_load_dwordx4 v[180:183], v9, s[36:39], s54 offen nt
    s_waitcnt vmcnt(8)
    s_bitcmp1_b32 s58, 30
    s_cbranch_scc1 L_bo31
    s_waitcnt vmcnt(5)
L_bo31:
    buffer_load_dwordx4 v[184:187], v10, s[36:39], s54 offen nt
    s_waitcnt vmcnt(8)
    s_bitcmp1_b32 s58, 31
    s_cbranch_scc1 L_bo32
    s_waitcnt vmcnt(5)
L_bo32:
    buffer_load_dwordx4 v[188:191], v7, s[36:39], s54 offen nt
    s_or_b32 s53, s53, 0xffe977ff
    s_add_u32 s53, s53, 1
    s_and_b32 s53, s53, 0x168800
    s_add_u32 s55, s55, 1
    s_cmp_lt_u32 s55, 3
    s_cbranch_scc1 L_vloop
    v_and_b32 v13, 7, v3
    v_lshlrev_b32 v13, 7, v13
    v_lshl_add_u32 v13, v4, 6, v13
    v_and_b32 v12, 8, v3
    s_lshl_b32 s54, s33, 4
    v_add3_u32 v13, v13, v12, s54
    v_and_b32_dpp v40, v32, v56 row_newbcast:0 row_mask:0xf bank_mask:0xf
    v_and_b32_dpp v41, v32, v57 row_newbcast:0 row_mask:0xf bank_mask:0xf
    v_and_b32_dpp v42, v32, v58 row_newbcast:0 row_mask:0xf bank_mask:0xf
    v_and_b32_dpp v43, v32, v59 row_newbcast:0 row_mask:0xf bank_mask:0xf
    s_waitcnt vmcnt(28)
    v_and_b32_dpp v44, v32, v56 row_newbcast:1 row_mask:0xf bank_mask:0xf
    v_and_b32_dpp v45, v32, v57 row_newbcast:1 row_mask:0xf bank_mask:0xf
    v_and_b32_dpp v46, v32, v58 row_newbcast:1 row_mask:0xf bank_mask:0xf
    v_and_b32_dpp v47, v32, v59 row_newbcast:1 row_mask:0xf bank_mask:0xf
    v_mfma_f32_16x16x32_bf16 v[48:51], v[40:43], v[64:67], v[48:51]
    v_and_b32_dpp v40, v32, v56 row_newbcast:2 row_mask:0xf bank_mask:0xf
    v_and_b32_dpp v41, v32, v57 row_newbcast:2 row_mask:0xf bank_mask:0xf
    v_and_b32_dpp v42, v32, v58 row_newbcast:2 row_mask:0xf bank_mask:0xf
    v_and_b32_dpp v43, v32, v59 row_newbcast:2 row_mask:0xf bank_mask:0xf
    v_mfma_f32_16x16x32_bf16 v[48:51], v[44:47], v[68:71], v[48:51]
    v_and_b32_dpp v44, v32, v56 row_newbcast:3 row_mask:0xf bank_mask:0xf
    v_and_b32_dpp v45, v32, v57 row_newbcast:3 row_mask:0xf bank_mask:0xf
    v_and_b32_dpp v46, v32, v58 row_newbcast:3 row_mask:0xf bank_mask:0xf
    v_and_b32_dpp v47, v32, v59 row_newbcast:3 row_mask:0xf bank_mask:0xf
    v_mfma_f32_16x16x32_bf16 v[48:51], v[40:43], v[72:75], v[48:51]
    v_and_b32_dpp v40, v32, v56 row_newbcast:4 row_mask:0xf bank_mask:0xf
    v_and_b32_dpp v41, v32, v57 row_newbcast:4 row_mask:0xf bank_mask:0xf
    v_and_b32_dpp v42, v32, v58 row_newbcast:4 row_mask:0xf bank_mask:0xf
    v_and_b32_dpp v43, v32, v59 row_newbcast:4 row_mask:0xf bank_mask:0xf
    v_mfma_f32_16x16x32_bf16 v[48:51], v[44:47], v[76:79], v[48:51]
    s_waitcnt vmcnt(24)
    v_and_b32_dpp v44, v32, v56 row_newbcast:5 row_mask:0xf bank_mask:0xf
    v_and_b32_dpp v45, v32, v57 row_newbcast:5 row_mask:0xf bank_mask:0xf
    v_and_b32_dpp v46, v32, v58 row_newbcast:5 row_mask:0xf bank_mask:0xf
    v_and_b32_dpp v47, v32, v59 row_newbcast:5 row_mask:0xf bank_mask:0xf
    v_mfma_f32_16x16x32_bf16 v[48:51], v[40:43], v[80:83], v[48:51]
    v_and_b32_dpp v40, v32, v56 row_newbcast:6 row_mask:0xf bank_mask:0xf
    v_and_b32_dpp v41, v32, v57 row_newbcast:6 row_mask:0xf bank_mask:0xf
    v_and_b32_dpp v42, v32, v58 row_newbcast:6 row_mask:0xf bank_mask:0xf
    v_and_b32_dpp v43, v32, v59 row_newbcast:6 row_mask:0xf bank_mask:0xf
    v_mfma_f32_16x16x32_bf16 v[48:51], v[44:47], v[84:87], v[48:51]
    v_and_b32_dpp v44, v32, v56 row_newbcast:7 row_mask:0xf bank_mask:0xf
    v_and_b32_dpp v45, v32, v57 row_newbcast:7 row_mask:0xf bank_mask:0xf
    v_and_b32_dpp v46, v32, v58 row_newbcast:7 row_mask:0xf bank_mask:0xf
    v_and_b32_dpp v47, v32, v59 row_newbcast:7 row_mask:0xf bank_mask:0xf
    v_mfma_f32_16x16x32_bf16 v[48:51], v[40:43], v[88:91], v[48:51]
    v_and_b32_dpp v40, v32, v56 row_newbcast:8 row_mask:0xf bank_mask:0xf
    v_and_b32_dpp v41, v32, v57 row_newbcast:8 row_mask:0xf bank_mask:0xf
    v_and_b32_dpp v42, v32, v58 row_newbcast:8 row_mask:0xf bank_mask:0xf
    v_and_b32_dpp v43, v32, v59 row_newbcast:8 row_mask:0xf bank_mask:0xf
    v_mfma_f32_16x16x32_bf16 v[48:51], v[44:47], v[92:95], v[48:51]
    s_waitcnt vmcnt(20)
    v_and_b32_dpp v44, v32, v56 row_newbcast:9 row_mask:0xf bank_mask:0xf
    v_and_b32_dpp v45, v32, v57 row_newbcast:9 row_mask:0xf bank_mask:0xf
    v_and_b32_dpp v46, v32, v58 row_newbcast:9 row_mask:0xf bank_mask:0xf
    v_and_b32_dpp v47, v32, v59 row_newbcast:9 row_mask:0xf bank_mask:0xf
    v_mfma_f32_16x16x32_bf16 v[48:51], v[40:43], v[96:99], v[48:51]
    v_and_b32_dpp v40, v32, v56 row_newbcast:10 row_mask:0xf bank_mask:0xf
    v_and_b32_dpp v41, v32, v57 row_newbcast:10 row_mask:0xf bank_mask:0xf
    v_and_b32_dpp v42, v32, v58 row_newbcast:10 row_mask:0xf bank_mask:0xf
    v_and_b32_dpp v43, v32, v59 row_newbcast:10 row_mask:0xf bank_mask:0xf
    v_mfma_f32_16x16x32_bf16 v[48:51], v[44:47], v[100:103], v[48:51]
    v_and_b32_dpp v44, v32, v56 row_newbcast:11 row_mask:0xf bank_mask:0xf
    v_and_b32_dpp v45, v32, v57 row_newbcast:11 row_mask:0xf bank_mask:0xf
    v_and_b32_dpp v46, v32, v58 row_newbcast:11 row_mask:0xf bank_mask:0xf
    v_and_b32_dpp v47, v32, v59 row_newbcast:11 row_mask:0xf bank_mask:0xf
    v_mfma_f32_16x16x32_bf16 v[48:51], v[40:43], v[104:107], v[48:51]
    v_and_b32_dpp v40, v32, v56 row_newbcast:12 row_mask:0xf bank_mask:0xf
    v_and_b32_dpp v41, v32, v57 row_newbcast:12 row_mask:0xf bank_mask:0xf
    v_and_b32_dpp v42, v32, v58 row_newbcast:12 row_mask:0xf bank_mask:0xf
    v_and_b32_dpp v43, v32, v59 row_newbcast:12 row_mask:0xf bank_mask:0xf
    v_mfma_f32_16x16x32_bf16 v[48:51], v[44:47], v[108:111], v[48:51]
    s_waitcnt vmcnt(16)
    v_and_b32_dpp v44, v32, v56 row_newbcast:13 row_mask:0xf bank_mask:0xf
    v_and_b32_dpp v45, v32, v57 row_newbcast:13 row_mask:0xf bank_mask:0xf
    v_and_b32_dpp v46, v32, v58 row_newbcast:13 row_mask:0xf bank_mask:0xf
    v_and_b32_dpp v47, v32, v59 row_newbcast:13 row_mask:0xf bank_mask:0xf
    v_mfma_f32_16x16x32_bf16 v[48:51], v[40:43], v[112:115], v[48:51]
    v_and_b32_dpp v40, v32, v56 row_newbcast:14 row_mask:0xf bank_mask:0xf
    v_and_b32_dpp v41, v32, v57 row_newbcast:14 row_mask:0xf bank_mask:0xf
    v_and_b32_dpp v42, v32, v58 row_newbcast:14 row_mask:0xf bank_mask:0xf
    v_and_b32_dpp v43, v32, v59 row_newbcast:14 row_mask:0xf bank_mask:0xf
    v_mfma_f32_16x16x32_bf16 v[48:51], v[44:47], v[116:119], v[48:51]
    v_and_b32_dpp v44, v32, v56 row_newbcast:15 row_mask:0xf bank_mask:0xf
    v_and_b32_dpp v45, v32, v57 row_newbcast:15 row_mask:0xf bank_mask:0xf
    v_and_b32_dpp v46, v32, v58 row_newbcast:15 row_mask:0xf bank_mask:0xf
    v_and_b32_dpp v47, v32, v59 row_newbcast:15 row_mask:0xf bank_mask:0xf
    v_mfma_f32_16x16x32_bf16 v[48:51], v[40:43], v[120:123], v[48:51]
    v_and_b32_dpp v40, v33, v56 row_newbcast:0 row_mask:0xf bank_mask:0xf
    v_and_b32_dpp v41, v33, v57 row_newbcast:0 row_mask:0xf bank_mask:0xf
    v_and_b32_dpp v42, v33, v58 row_newbcast:0 row_mask:0xf bank_mask:0xf
    v_and_b32_dpp v43, v33, v59 row_newbcast:0 row_mask:0xf bank_mask:0xf
    v_mfma_f32_16x16x32_bf16 v[48:51], v[44:47], v[124:127], v[48:51]
    s_waitcnt vmcnt(12)
    v_and_b32_dpp v44, v33, v56 row_newbcast:1 row_mask:0xf bank_mask:0xf
    v_and_b32_dpp v45, v33, v57 row_newbcast:1 row_mask:0xf bank_mask:0xf
    v_and_b32_dpp v46, v33, v58 row_newbcast:1 row_mask:0xf bank_mask:0xf
    v_and_b32_dpp v47, v33, v59 row_newbcast:1 row_mask:0xf bank_mask:0xf
    v_mfma_f32_16x16x32_bf16 v[48:51], v[40:43], v[128:131], v[48:51]
    v_and_b32_dpp v40, v33, v56 row_newbcast:2 row_mask:0xf bank_mask:0xf
    v_and_b32_dpp v41, v33, v57 row_newbcast:2 row_mask:0xf bank_mask:0xf
    v_and_b32_dpp v42, v33, v58 row_newbcast:2 row_mask:0xf bank_mask:0xf
    v_and_b32_dpp v43, v33, v59 row_newbcast:2 row_mask:0xf bank_mask:0xf
    v_mfma_f32_16x16x32_bf16 v[48:51], v[44:47], v[132:135], v[48:51]
    v_and_b32_dpp v44, v33, v56 row_newbcast:3 row_mask:0xf bank_mask:0xf
    v_and_b32_dpp v45, v33, v57 row_newbcast:3 row_mask:0xf bank_mask:0xf
    v_and_b32_dpp v46, v33, v58 row_newbcast:3 row_mask:0xf bank_mask:0xf
    v_and_b32_dpp v47, v33, v59 row_newbcast:3 row_mask:0xf bank_mask:0xf
    v_mfma_f32_16x16x32_bf16 v[48:51], v[40:43], v[136:139], v[48:51]
    v_and_b32_dpp v40, v33, v56 row_newbcast:4 row_mask:0xf bank_mask:0xf
    v_and_b32_dpp v41, v33, v57 row_newbcast:4 row_mask:0xf bank_mask:0xf
    v_and_b32_dpp v42, v33, v58 row_newbcast:4 row_mask:0xf bank_mask:0xf
    v_and_b32_dpp v43, v33, v59 row_newbcast:4 row_mask:0xf bank_mask:0xf
    v_mfma_f32_16x16x32_bf16 v[48:51], v[44:47], v[140:143], v[48:51]
    v_and_b32_dpp v44, v33, v56 row_newbcast:5 row_mask:0xf bank_mask:0xf
    v_and_b32_dpp v45, v33, v57 row_newbcast:5 row_mask:0xf bank_mask:0xf
    v_and_b32_dpp v46, v33, v58 row_newbcast:5 row_mask:0xf bank_mask:0xf
    v_and_b32_dpp v47, v33, v59 row_newbcast:5 row_mask:0xf bank_mask:0xf
    s_waitcnt vmcnt(11)
    v_mfma_f32_16x16x32_bf16 v[48:51], v[40:43], v[144:147], v[48:51]
    v_and_b32_dpp v40, v33, v56 row_newbcast:6 row_mask:0xf bank_mask:0xf
    v_and_b32_dpp v41, v33, v57 row_newbcast:6 row_mask:0xf bank_mask:0xf
    v_and_b32_dpp v42, v33, v58 row_newbcast:6 row_mask:0xf bank_mask:0xf
    v_and_b32_dpp v43, v33, v59 row_newbcast:6 row_mask:0xf bank_mask:0xf
    s_waitcnt vmcnt(10)
    v_mfma_f32_16x16x32_bf16 v[48:51], v[44:47], v[148:151], v[48:51]
    v_and_b32_dpp v44, v33, v56 row_newbcast:7 row_mask:0xf bank_mask:0xf
    v_and_b32_dpp v45, v33, v57 row_newbcast:7 row_mask:0xf bank_mask:0xf
    v_and_b32_dpp v46, v33, v58 row_newbcast:7 row_mask:0xf bank_mask:0xf
    v_and_b32_dpp v47, v33, v59 row_newbcast:7 row_mask:0xf bank_mask:0xf
    s_waitcnt vmcnt(9)
    v_mfma_f32_16x16x32_bf16 v[48:51], v[40:43], v[152:155], v[48:51]
    v_and_b32_dpp v40, v33, v56 row_newbcast:8 row_mask:0xf bank_mask:0xf
    v_and_b32_dpp v41, v33, v57 row_newbcast:8 row_mask:0xf bank_mask:0xf
    v_and_b32_dpp v42, v33, v58 row_newbcast:8 row_mask:0xf bank_mask:0xf
    v_and_b32_dpp v43, v33, v59 row_newbcast:8 row_mask:0xf bank_mask:0xf
    s_waitcnt vmcnt(8)
    v_mfma_f32_16x16x32_bf16 v[48:51], v[44:47], v[156:159], v[48:51]
    v_and_b32_dpp v44, v33, v56 row_newbcast:9 row_mask:0xf bank_mask:0xf
    v_and_b32_dpp v45, v33, v57 row_newbcast:9 row_mask:0xf bank_mask:0xf
    v_and_b32_dpp v46, v33, v58 row_newbcast:9 row_mask:0xf bank_mask:0xf
    v_and_b32_dpp v47, v33, v59 row_newbcast:9 row_mask:0xf bank_mask:0xf
    s_waitcnt vmcnt(7)
    v_mfma_f32_16x16x32_bf16 v[48:51], v[40:43], v[160:163], v[48:51]
    v_and_b32_dpp v40, v33, v56 row_newbcast:10 row_mask:0xf bank_mask:0xf
    v_and_b32_dpp v41, v33, v57 row_newbcast:10 row_mask:0xf bank_mask:0xf
    v_and_b32_dpp v42, v33, v58 row_newbcast:10 row_mask:0xf bank_mask:0xf
    v_and_b32_dpp v43, v33, v59 row_newbcast:10 row_mask:0xf bank_mask:0xf
    s_waitcnt vmcnt(6)
    v_mfma_f32_16x16x32_bf16 v[48:51], v[44:47], v[164:167], v[48:51]
    v_and_b32_dpp v44, v33, v56 row_newbcast:11 row_mask:0xf bank_mask:0xf
    v_and_b32_dpp v45, v33, v57 row_newbcast:11 row_mask:0xf bank_mask:0xf
    v_and_b32_dpp v46, v33, v58 row_newbcast:11 row_mask:0xf bank_mask:0xf
    v_and_b32_dpp v47, v33, v59 row_newbcast:11 row_mask:0xf bank_mask:0xf
    s_waitcnt vmcnt(5)
    v_mfma_f32_16x16x32_bf16 v[48:51], v[40:43], v[168:171], v[48:51]
    v_and_b32_dpp v40, v33, v56 row_newbcast:12 row_mask:0xf bank_mask:0xf
    v_and_b32_dpp v41, v33, v57 row_newbcast:12 row_mask:0xf bank_mask:0xf
    v_and_b32_dpp v42, v33, v58 row_newbcast:12 row_mask:0xf bank_mask:0xf
    v_and_b32_dpp v43, v33, v59 row_newbcast:12 row_mask:0xf bank_mask:0xf
    s_waitcnt vmcnt(4)
    v_mfma_f32_16x16x32_bf16 v[48:51], v[44:47], v[172:175], v[48:51]
    v_and_b32_dpp v44, v33, v56 row_newbcast:13 row_mask:0xf bank_mask:0xf
    v_and_b32_dpp v45, v33, v57 row_newbcast:13 row_mask:0xf bank_mask:0xf
    v_and_b32_dpp v46, v33, v58 row_newbcast:13 row_mask:0xf bank_mask:0xf
    v_and_b32_dpp v47, v33, v59 row_newbcast:13 row_mask:0xf bank_mask:0xf
    s_waitcnt vmcnt(3)
    v_mfma_f32_16x16x32_bf16 v[48:51], v[40:43], v[176:179], v[48:51]
    v_and_b32_dpp v40, v33, v56 row_newbcast:14 row_mask:0xf bank_mask:0xf
    v_and_b32_dpp v41, v33, v57 row_newbcast:14 row_mask:0xf bank_mask:0xf
    v_and_b32_dpp v42, v33, v58 row_newbcast:14 row_mask:0xf bank_mask:0xf
    v_and_b32_dpp v43, v33, v59 row_newbcast:14 row_mask:0xf bank_mask:0xf
    s_waitcnt vmcnt(2)
    v_mfma_f32_16x16x32_bf16 v[48:51], v[44:47], v[180:183], v[48:51]
    v_and_b32_dpp v44, v33, v56 row_newbcast:15 row_mask:0xf bank_mask:0xf
    v_and_b32_dpp v45, v33, v57 row_newbcast:15 row_mask:0xf bank_mask:0xf
    v_and_b32_dpp v46, v33, v58 row_newbcast:15 row_mask:0xf bank_mask:0xf
    v_and_b32_dpp v47, v33, v59 row_newbcast:15 row_mask:0xf bank_mask:0xf
    s_waitcnt vmcnt(1)
    v_mfma_f32_16x16x32_bf16 v[48:51], v[40:43], v[184:187], v[48:51]
    s_nop 1
    s_waitcnt vmcnt(0)
    v_mfma_f32_16x16x32_bf16 v[48:51], v[44:47], v[188:191], v[48:51]
    s_mov_b32 exec_hi, 0
    s_nop 6
    v_cvt_pk_bf16_f32 v48, v48, v49
    v_cvt_pk_bf16_f32 v49, v50, v51
    ds_write_b64 v13, v[48:49] offset:2304
    s_waitcnt lgkmcnt(0)
    s_barrier
L_end:
    s_endpgm
.section .rodata,"a"
.p2align 6
.amdhsa_kernel concat_heads__mha_block_cached__gqa_block_cached__decode_kernel
  .amdhsa_next_free_vgpr 256
  .amdhsa_next_free_sgpr 102
  .amdhsa_accum_offset 256
  .amdhsa_group_segment_fixed_size 0
  .amdhsa_kernarg_size 104
  .amdhsa_user_sgpr_count 2
  .amdhsa_user_sgpr_kernarg_segment_ptr 1
  .amdhsa_system_sgpr_workgroup_id_x 1
  .amdhsa_float_denorm_mode_32 3
.end_amdhsa_kernel
```
